```python
import torch

def _softmax(x, axis=-1):
    return torch.softmax(x, dim=axis)
def _gelu(x):
    return torch.nn.functional.gelu(x, approximate="tanh")
def _silu(x):
    return torch.nn.functional.silu(x)
def _sigmoid(x):
    return torch.sigmoid(x)
def _layernorm(x, axis=-1, eps=1e-5):
    m = x.mean(dim=axis, keepdim=True)
    v = x.var(dim=axis, keepdim=True, unbiased=False)
    return (x - m) / torch.sqrt(v + eps)
def _scatter_add(tgt, idx, src, axis=0):
    return tgt.clone().index_add_(axis, idx, src)
def _segment_sum(src, seg, n):
    out = torch.zeros((n,) + src.shape[1:], dtype=src.dtype)
    return out.index_add_(0, seg, src)
def _pad(x, pw):
    flat = tuple(v for pair in reversed(pw) for v in pair)
    return torch.nn.functional.pad(x, flat)

kernel_name = 'sequential_preLN__sliding_local_dilated__glu_gated_glu__prompt'

def setup_inputs():

    _w = (lambda a: (lambda t: t.to(torch.bfloat16) if t.is_floating_point() else t)(torch.as_tensor(a)))
    def _A_setup():
        B, S, D = 1, 2048, 448
        return {
            "x": _w((lambda *s: torch.randn(*s, dtype=torch.bfloat16) * 0.05)(B, S, D)),
            "wqkv": _w((lambda *s: torch.randn(*s, dtype=torch.bfloat16) * 0.05)(D, 3 * D)),
            "wo": _w((lambda *s: torch.randn(*s, dtype=torch.bfloat16) * 0.05)(D, D)),
        }
    _A_in = _A_setup()

    def _B_setup():
        B, S, D, F = 1, 2048, 448, 1792
        return {
            "x": _w((lambda *s: torch.randn(*s, dtype=torch.bfloat16) * 0.05)(B, S, D)),
            "w_gate": _w((lambda *s: torch.randn(*s, dtype=torch.bfloat16) * 0.05)(D, F)),
            "w_up": _w((lambda *s: torch.randn(*s, dtype=torch.bfloat16) * 0.05)(D, F)),
            "w_down": _w((lambda *s: torch.randn(*s, dtype=torch.bfloat16) * 0.05)(F, D)),
        }
    _B_in = _B_setup()

    return {
        "A_x": _A_in["x"],
        "A_wqkv": _A_in["wqkv"],
        "A_wo": _A_in["wo"],
        "B_x": _B_in["x"],
        "B_w_gate": _B_in["w_gate"],
        "B_w_up": _B_in["w_up"],
        "B_w_down": _B_in["w_down"],
    }

def reference(A_x, A_wqkv, A_wo, B_x, B_w_gate, B_w_up, B_w_down):
    def _A_ref(x, wqkv, wo):
        B, S, D = x.shape
        H = 16; Dh = D // H
        W, dil = 8, 2
        qkv = (lambda x, *d: x.permute(*d))((x @ wqkv).reshape(B, S, 3, H, Dh), 2, 0, 3, 1, 4)
        q, k, v = qkv[0], qkv[1], qkv[2]
        scale = Dh ** -0.5
        pos = torch.arange(S)
        off = torch.arange(W) * dil
        idx = pos[:, None] - off[None, :]
        mask = idx >= 0
        idx_c = torch.where(mask, idx, 0).reshape(-1)
        kg = k[:, :, idx_c, :].reshape(B, H, S, W, Dh)
        vg = v[:, :, idx_c, :].reshape(B, H, S, W, Dh)
        logits = torch.einsum("bhsd,bhswd->bhsw", q, kg) * scale
        logits = torch.where(mask[None, None, :, :], logits, -1e9)
        attn = _softmax(logits, axis=-1)
        o = torch.einsum("bhsw,bhswd->bhsd", attn, vg)
        return (lambda x, *d: x.permute(*d))(o, 0, 2, 1, 3).reshape(B, S, D) @ wo

    def _B_ref(x, w_gate, w_up, w_down):
        g = torch.einsum("bsd,df->bsf", x, w_gate)
        u = torch.einsum("bsd,df->bsf", x, w_up)
        h = _sigmoid(g) * u
        return torch.einsum("bsf,fd->bsd", h, w_down)

    x = A_x
    h = x + _A_ref(_layernorm(x, axis=-1), A_wqkv, A_wo)
    h2 = h + _B_ref(_layernorm(h, axis=-1), B_w_gate, B_w_up, B_w_down)
    return h2
```

```asm
; @launch grid=(256,1,1) block=(512,1,1) lds=163840
.amdgcn_target "amdgcn-amd-amdhsa--gfx950"
.text
.globl sequential_preLN__sliding_local_dilated__glu_gated_glu__prompt_kernel
.p2align 8
.type sequential_preLN__sliding_local_dilated__glu_gated_glu__prompt_kernel,@function
sequential_preLN__sliding_local_dilated__glu_gated_glu__prompt_kernel:
Lcode_begin:
  s_load_dwordx16 s[64:79], s[0:1], 0
  s_load_dwordx4 s[80:83], s[0:1], 64
  s_memrealtime s[4:5]
  s_cmp_ge_u32 s2, 256
  s_cbranch_scc1 Lend
  s_getpc_b64 s[6:7]
  v_and_b32 v1, 63, v0
  v_lshrrev_b32 v6, 6, v0
  v_lshrrev_b32 v2, 4, v1
  v_readfirstlane_b32 s44, v6
  v_and_b32 v3, 15, v0
  v_bfe_u32 v4, v0, 2, 2
  v_and_b32 v5, 3, v0
  s_and_b32 s45, s2, 7
  s_lshr_b32 s46, s2, 3
  v_lshlrev_b32 v6, 7, v0
  v_min_u32 v6, 23704, v6
  s_cmp_gt_u32 s44, 3
  s_cbranch_scc1 Lnopf
  global_load_dword v7, v6, s[6:7]
Lnopf:
  s_mov_b32 s10, 1835008
  s_mov_b32 s11, 0x00020000
  s_mov_b32 s14, 1204224
  s_mov_b32 s15, 0x00020000
  s_mov_b32 s18, 401408
  s_mov_b32 s19, 0x00020000
  s_mov_b32 s22, 1605632
  s_mov_b32 s23, 0x00020000
  s_mov_b32 s26, 1605632
  s_mov_b32 s27, 0x00020000
  s_mov_b32 s30, 1605632
  s_mov_b32 s31, 0x00020000
  s_mov_b32 s34, 1835008
  s_mov_b32 s35, 0x00020000
  s_mov_b32 s38, 33554432
  s_mov_b32 s39, 0x00020000
  s_mov_b32 s42, 256
  s_mov_b32 s43, 0x00020000
  s_lshl_b32 s53, s44, 10
  s_mul_i32 s55, s46, 37
  s_lshr_b32 s55, s55, 8
  s_mul_i32 s56, s55, 7
  s_sub_u32 s56, s46, s56
  s_add_u32 s49, s56, 1
  s_cmp_lt_u32 s46, 28
  s_cselect_b32 s49, s49, 0
  s_cselect_b32 s55, s55, s56
  s_lshl_b32 s48, s45, 2
  s_add_u32 s48, s48, s55
  s_lshl_b32 s50, s48, 6
  s_and_b32 s51, s44, 3
  s_lshr_b32 s52, s44, 2
  v_lshrrev_b32 v12, 3, v1
  v_and_b32 v13, 7, v1
  v_lshlrev_b32 v14, 4, v1
  s_cmp_lt_u32 s44, 4
  s_cbranch_scc1 LAcons
  s_lshl_b32 s54, s51, 11
  v_and_b32 v8, 2, v12
  v_xor_b32 v8, v8, v13
  v_xor_b32 v10, 4, v8
  v_min_u32 v8, 6, v8
  v_min_u32 v10, 6, v10
  s_lshl_b32 s55, s51, 4
  v_add_u32 v9, s55, v12
  v_mul_u32_u24 v9, 2688, v9
  s_mul_i32 s55, s49, 112
  v_add_u32 v9, s55, v9
  v_lshl_add_u32 v40, v8, 4, v9
  v_add_u32 v9, 21504, v9
  v_lshl_add_u32 v41, v10, 4, v9
  s_lshr_b32 s56, s51, 1
  s_and_b32 s57, s51, 1
  s_lshl_b32 s55, s56, 5
  s_add_u32 s55, s55, s50
  s_add_u32 s55, s55, s57
  v_lshl_add_u32 v9, v12, 1, s55
  v_mul_u32_u24 v9, 896, v9
  v_lshrrev_b32 v8, 1, v12
  v_xor_b32 v8, v8, v13
  v_lshl_add_u32 v42, v8, 4, v9
  v_xor_b32 v8, 4, v8
  v_add_u32 v9, 14336, v9
  v_lshl_add_u32 v43, v8, 4, v9
  s_lshl_b32 s55, s57, 3
  s_add_u32 s55, s55, s56
  s_add_u32 s55, s55, s50
  s_sub_u32 s55, s55, 16
  v_and_b32 v8, 3, v12
  v_lshl_add_u32 v9, v8, 1, s55
  v_max_i32 v9, 0, v9
  v_mul_u32_u24 v9, 896, v9
  v_lshrrev_b32 v8, 1, v8
  s_lshl_b32 s55, s51, 1
  v_add_u32 v8, s55, v8
  v_xor_b32 v8, v8, v13
  v_lshl_add_u32 v44, v8, 4, v9
  s_mov_b32 s59, 0
  s_cmp_eq_u32 s51, 0
  s_cselect_b32 s58, 0xffffff00, -1
  s_waitcnt lgkmcnt(0)
  s_mov_b64 s[8:9], s[64:65]
  s_mov_b64 s[12:13], s[66:67]
  s_mov_b64 s[16:17], s[68:69]
  s_mov_b64 s[20:21], s[72:73]
  s_mov_b64 s[24:25], s[74:75]
  s_mov_b64 s[28:29], s[76:77]
  s_mov_b64 s[32:33], s[78:79]
  s_mov_b64 s[36:37], s[82:83]
  s_mov_b64 s[40:41], s[80:81]
  s_lshl_b32 s65, s51, 9
  s_mov_b32 s67, 0
  s_setprio 3
  s_add_u32 m0, s65, 67584
  s_mov_b64 exec, s[58:59]
  buffer_load_dwordx4 v44, s[8:11], s67 offen lds
  s_mov_b64 exec, -1
  s_add_u32 m0, s54, 59392
  s_nop 0
  buffer_load_dwordx4 v42, s[8:11], s67 offen lds
  s_add_u32 m0, s54, 60416
  s_nop 0
  buffer_load_dwordx4 v43, s[8:11], s67 offen lds
  s_mul_i32 s64, s67, 1344
  s_add_u32 m0, s54, 34816
  s_nop 0
  buffer_load_dwordx4 v40, s[12:15], s64 offen offset:0 lds
  s_add_u32 m0, s54, 35840
  s_nop 0
  buffer_load_dwordx4 v41, s[12:15], s64 offen offset:0 lds
  s_add_u32 m0, s54, 42112
  s_nop 0
  buffer_load_dwordx4 v40, s[12:15], s64 offen offset:896 lds
  s_add_u32 m0, s54, 43136
  s_nop 0
  buffer_load_dwordx4 v41, s[12:15], s64 offen offset:896 lds
  s_add_u32 m0, s54, 49408
  s_nop 0
  buffer_load_dwordx4 v40, s[12:15], s64 offen offset:1792 lds
  s_add_u32 m0, s54, 50432
  s_nop 0
  buffer_load_dwordx4 v41, s[12:15], s64 offen offset:1792 lds
  v_mov_b32 v20, 0x3f803f80
  v_mov_b32 v21, 0x3f803f80
  v_mov_b32 v22, 0x3f803f80
  v_mov_b32 v23, 0x3f803f80
  v_and_b32 v8, 3, v12
  v_mul_u32_u24 v8, 34816, v8
  v_lshl_add_u32 v8, v13, 4, v8
  ds_write_b128 v8, v[20:23] offset:32768
  v_mov_b32 v48, 0
  v_mov_b32 v49, 0
  v_mov_b32 v50, 0
  v_mov_b32 v51, 0
  v_mov_b32 v52, 0
  v_mov_b32 v53, 0
  s_add_u32 s55, s54, 24576
  v_add_u32 v54, s55, v14
  v_add_u32 v55, 69632, v54
  s_add_u32 s55, s65, 32768
  v_add_u32 v56, s55, v14
  v_add_u32 v57, 69632, v56
  s_add_u32 s67, s67, 128
  s_cmp_eq_u32 s67, 896
  s_cselect_b32 s67, 0, s67
  s_add_u32 m0, s65, 102400
  s_mov_b64 exec, s[58:59]
  buffer_load_dwordx4 v44, s[8:11], s67 offen lds
  s_mov_b64 exec, -1
  s_add_u32 m0, s54, 94208
  s_nop 0
  buffer_load_dwordx4 v42, s[8:11], s67 offen lds
  s_add_u32 m0, s54, 95232
  s_nop 0
  buffer_load_dwordx4 v43, s[8:11], s67 offen lds
  s_mul_i32 s64, s67, 1344
  s_add_u32 m0, s54, 69632
  s_nop 0
  buffer_load_dwordx4 v40, s[12:15], s64 offen offset:0 lds
  s_add_u32 m0, s54, 70656
  s_nop 0
  buffer_load_dwordx4 v41, s[12:15], s64 offen offset:0 lds
  s_add_u32 m0, s54, 76928
  s_nop 0
  buffer_load_dwordx4 v40, s[12:15], s64 offen offset:896 lds
  s_add_u32 m0, s54, 77952
  s_nop 0
  buffer_load_dwordx4 v41, s[12:15], s64 offen offset:896 lds
  s_add_u32 m0, s54, 84224
  s_nop 0
  buffer_load_dwordx4 v40, s[12:15], s64 offen offset:1792 lds
  s_add_u32 m0, s54, 85248
  s_nop 0
  buffer_load_dwordx4 v41, s[12:15], s64 offen offset:1792 lds
  s_waitcnt vmcnt(15)
  ds_read_b128 v[84:87], v54 offset:34816
  ds_read_b128 v[88:91], v54 offset:35840
  ds_read_b128 v[92:95], v56 offset:34816
  s_waitcnt lgkmcnt(2)
  v_dot2c_f32_bf16 v48, v84, v20
  v_dot2c_f32_bf16 v49, v84, v84
  s_waitcnt lgkmcnt(1)
  v_dot2c_f32_bf16 v50, v88, v20
  v_dot2c_f32_bf16 v51, v88, v88
  s_waitcnt lgkmcnt(0)
  v_dot2c_f32_bf16 v52, v92, v20
  v_dot2c_f32_bf16 v53, v92, v92
  v_dot2c_f32_bf16 v48, v85, v20
  v_dot2c_f32_bf16 v49, v85, v85
  v_dot2c_f32_bf16 v50, v89, v20
  v_dot2c_f32_bf16 v51, v89, v89
  v_dot2c_f32_bf16 v52, v93, v20
  v_dot2c_f32_bf16 v53, v93, v93
  v_dot2c_f32_bf16 v48, v86, v20
  v_dot2c_f32_bf16 v49, v86, v86
  v_dot2c_f32_bf16 v50, v90, v20
  v_dot2c_f32_bf16 v51, v90, v90
  v_dot2c_f32_bf16 v52, v94, v20
  v_dot2c_f32_bf16 v53, v94, v94
  v_dot2c_f32_bf16 v48, v87, v20
  v_dot2c_f32_bf16 v49, v87, v87
  v_dot2c_f32_bf16 v50, v91, v20
  v_dot2c_f32_bf16 v51, v91, v91
  v_dot2c_f32_bf16 v52, v95, v20
  v_dot2c_f32_bf16 v53, v95, v95
  s_waitcnt vmcnt(9)
  s_barrier
  s_waitcnt vmcnt(6)
  ds_read_b128 v[84:87], v55 offset:0
  ds_read_b128 v[88:91], v55 offset:1024
  ds_read_b128 v[92:95], v57 offset:0
  s_add_u32 s67, s67, 128
  s_cmp_eq_u32 s67, 896
  s_cselect_b32 s67, 0, s67
  s_add_u32 m0, s65, 137216
  s_mov_b64 exec, s[58:59]
  buffer_load_dwordx4 v44, s[8:11], s67 offen lds
  s_mov_b64 exec, -1
  s_add_u32 m0, s54, 129024
  s_nop 0
  buffer_load_dwordx4 v42, s[8:11], s67 offen lds
  v_lshlrev_b32 v8, 2, v2
  v_sub_u32 v9, v3, v8
  s_lshl_b32 s55, s48, 2
  s_add_u32 s55, s55, s51
  s_cmp_lt_u32 s55, 2
  s_cselect_b32 s56, 0x10000, 0
  v_mov_b32 v11, 0xff800000
  v_subrev_u32 v10, 0, v9
  s_add_u32 m0, s54, 130048
  s_nop 0
  buffer_load_dwordx4 v43, s[8:11], s67 offen lds
  v_cmp_gt_u32 vcc, 8, v10
  s_nop 1
  v_cndmask_b32 v80, v11, 0, vcc
  v_add_u32 v10, 16, v10
  v_add_u32 v10, s56, v10
  v_cmp_gt_u32 vcc, 8, v10
  s_nop 1
  v_cndmask_b32 v76, v11, 0, vcc
  v_subrev_u32 v10, 1, v9
  v_cmp_gt_u32 vcc, 8, v10
  s_nop 1
  v_cndmask_b32 v81, v11, 0, vcc
  v_add_u32 v10, 16, v10
  s_mul_i32 s64, s67, 1344
  s_add_u32 m0, s54, 104448
  s_nop 0
  buffer_load_dwordx4 v40, s[12:15], s64 offen offset:0 lds
  v_add_u32 v10, s56, v10
  v_cmp_gt_u32 vcc, 8, v10
  s_nop 1
  v_cndmask_b32 v77, v11, 0, vcc
  v_subrev_u32 v10, 2, v9
  v_cmp_gt_u32 vcc, 8, v10
  s_nop 1
  v_cndmask_b32 v82, v11, 0, vcc
  v_add_u32 v10, 16, v10
  v_add_u32 v10, s56, v10
  v_cmp_gt_u32 vcc, 8, v10
  s_nop 1
  v_cndmask_b32 v78, v11, 0, vcc
  s_add_u32 m0, s54, 105472
  s_nop 0
  buffer_load_dwordx4 v41, s[12:15], s64 offen offset:0 lds
  v_subrev_u32 v10, 3, v9
  v_cmp_gt_u32 vcc, 8, v10
  s_nop 1
  v_cndmask_b32 v83, v11, 0, vcc
  s_waitcnt lgkmcnt(2)
  v_dot2c_f32_bf16 v48, v84, v20
  v_dot2c_f32_bf16 v49, v84, v84
  s_waitcnt lgkmcnt(1)
  v_dot2c_f32_bf16 v50, v88, v20
  v_dot2c_f32_bf16 v51, v88, v88
  s_waitcnt lgkmcnt(0)
  v_dot2c_f32_bf16 v52, v92, v20
  s_add_u32 m0, s54, 111744
  s_nop 0
  buffer_load_dwordx4 v40, s[12:15], s64 offen offset:896 lds
  v_dot2c_f32_bf16 v53, v92, v92
  v_dot2c_f32_bf16 v48, v85, v20
  v_dot2c_f32_bf16 v49, v85, v85
  v_dot2c_f32_bf16 v50, v89, v20
  v_dot2c_f32_bf16 v51, v89, v89
  v_dot2c_f32_bf16 v52, v93, v20
  v_dot2c_f32_bf16 v53, v93, v93
  s_add_u32 m0, s54, 112768
  s_nop 0
  buffer_load_dwordx4 v41, s[12:15], s64 offen offset:896 lds
  v_dot2c_f32_bf16 v48, v86, v20
  v_dot2c_f32_bf16 v49, v86, v86
  v_dot2c_f32_bf16 v50, v90, v20
  v_dot2c_f32_bf16 v51, v90, v90
  v_dot2c_f32_bf16 v52, v94, v20
  v_dot2c_f32_bf16 v53, v94, v94
  v_dot2c_f32_bf16 v48, v87, v20
  s_add_u32 m0, s54, 119040
  s_nop 0
  buffer_load_dwordx4 v40, s[12:15], s64 offen offset:1792 lds
  v_dot2c_f32_bf16 v49, v87, v87
  v_dot2c_f32_bf16 v50, v91, v20
  v_dot2c_f32_bf16 v51, v91, v91
  v_dot2c_f32_bf16 v52, v95, v20
  v_dot2c_f32_bf16 v53, v95, v95
  s_add_u32 m0, s54, 120064
  s_nop 0
  buffer_load_dwordx4 v41, s[12:15], s64 offen offset:1792 lds
  s_waitcnt vmcnt(9)
  s_barrier
  s_waitcnt vmcnt(6)
  ds_read_b128 v[84:87], v55 offset:34816
  ds_read_b128 v[88:91], v55 offset:35840
  ds_read_b128 v[92:95], v57 offset:34816
  s_add_u32 s67, s67, 128
  s_cmp_eq_u32 s67, 896
  s_cselect_b32 s67, 0, s67
  s_add_u32 m0, s65, 32768
  s_mov_b64 exec, s[58:59]
  buffer_load_dwordx4 v44, s[8:11], s67 offen lds
  s_mov_b64 exec, -1
  s_add_u32 m0, s54, 24576
  s_nop 0
  buffer_load_dwordx4 v42, s[8:11], s67 offen lds
  v_add_u32 v10, 16, v10
  v_add_u32 v10, s56, v10
  v_cmp_gt_u32 vcc, 8, v10
  s_nop 1
  v_cndmask_b32 v79, v11, 0, vcc
  v_cmp_gt_u32 s[94:95], 3, v2
  s_mul_i32 s56, s52, 3072
  s_add_u32 s56, s56, 69632
  s_add_u32 m0, s54, 25600
  s_nop 0
  buffer_load_dwordx4 v43, s[8:11], s67 offen lds
  s_mul_i32 s55, s51, 6144
  s_add_u32 s55, s55, s56
  v_lshl_add_u32 v32, v1, 3, s55
  v_lshl_add_u32 v9, v2, 2, v4
  v_lshl_add_u32 v10, v5, 4, v9
  v_lshl_add_u32 v33, v10, 3, s55
  s_mul_i32 s64, s67, 1344
  s_add_u32 m0, s54, 0
  s_nop 0
  buffer_load_dwordx4 v40, s[12:15], s64 offen offset:0 lds
  s_sub_u32 s55, s55, 12288
  s_add_u32 s56, s56, 24576
  s_lshl_b32 s97, s51, 3
  s_lshl_b32 s57, s51, 6
  s_add_u32 s57, s57, 139648
  v_lshl_add_u32 v36, v3, 2, s57
  s_add_u32 m0, s54, 1024
  s_nop 0
  buffer_load_dwordx4 v41, s[12:15], s64 offen offset:0 lds
  v_lshl_add_u32 v37, v2, 4, s57
  s_sub_u32 s57, s57, 128
  s_cmp_lt_u32 s51, 2
  s_cselect_b32 s96, 7, 15
  s_cselect_b32 s97, s97, 0
  s_cselect_b32 s55, s56, s55
  s_cselect_b32 s57, 139904, s57
  v_and_b32 v9, s96, v9
  v_add_u32 v9, s97, v9
  v_lshl_add_u32 v10, v5, 4, v9
  s_add_u32 m0, s54, 7296
  s_nop 0
  buffer_load_dwordx4 v40, s[12:15], s64 offen offset:896 lds
  s_waitcnt lgkmcnt(2)
  v_dot2c_f32_bf16 v48, v84, v20
  v_dot2c_f32_bf16 v49, v84, v84
  s_waitcnt lgkmcnt(1)
  v_dot2c_f32_bf16 v50, v88, v20
  v_dot2c_f32_bf16 v51, v88, v88
  s_waitcnt lgkmcnt(0)
  v_dot2c_f32_bf16 v52, v92, v20
  v_dot2c_f32_bf16 v53, v92, v92
  s_add_u32 m0, s54, 8320
  s_nop 0
  buffer_load_dwordx4 v41, s[12:15], s64 offen offset:896 lds
  v_dot2c_f32_bf16 v48, v85, v20
  v_dot2c_f32_bf16 v49, v85, v85
  v_dot2c_f32_bf16 v50, v89, v20
  v_dot2c_f32_bf16 v51, v89, v89
  v_dot2c_f32_bf16 v52, v93, v20
  v_dot2c_f32_bf16 v53, v93, v93
  s_add_u32 m0, s54, 14592
  s_nop 0
  buffer_load_dwordx4 v40, s[12:15], s64 offen offset:1792 lds
  v_dot2c_f32_bf16 v48, v86, v20
  v_dot2c_f32_bf16 v49, v86, v86
  v_dot2c_f32_bf16 v50, v90, v20
  v_dot2c_f32_bf16 v51, v90, v90
  v_dot2c_f32_bf16 v52, v94, v20
  v_dot2c_f32_bf16 v53, v94, v94
  s_add_u32 m0, s54, 15616
  s_nop 0
  buffer_load_dwordx4 v41, s[12:15], s64 offen offset:1792 lds
  v_dot2c_f32_bf16 v48, v87, v20
  v_dot2c_f32_bf16 v49, v87, v87
  v_dot2c_f32_bf16 v50, v91, v20
  v_dot2c_f32_bf16 v51, v91, v91
  v_dot2c_f32_bf16 v52, v95, v20
  v_dot2c_f32_bf16 v53, v95, v95
  s_waitcnt vmcnt(9)
  s_barrier
  s_waitcnt vmcnt(6)
  ds_read_b128 v[84:87], v54 offset:0
  ds_read_b128 v[88:91], v54 offset:1024
  ds_read_b128 v[92:95], v56 offset:0
  s_add_u32 s67, s67, 128
  s_cmp_eq_u32 s67, 896
  s_cselect_b32 s67, 0, s67
  s_add_u32 m0, s65, 67584
  s_mov_b64 exec, s[58:59]
  buffer_load_dwordx4 v44, s[8:11], s67 offen lds
  s_mov_b64 exec, -1
  s_add_u32 m0, s54, 59392
  s_nop 0
  buffer_load_dwordx4 v42, s[8:11], s67 offen lds
  v_lshl_add_u32 v34, v10, 3, s55
  v_and_b32 v9, s96, v8
  v_add_u32 v9, s97, v9
  v_lshl_add_u32 v38, v9, 2, s57
  v_and_b32 v9, s96, v3
  v_add_u32 v9, s97, v9
  s_add_u32 m0, s54, 60416
  s_nop 0
  buffer_load_dwordx4 v43, s[8:11], s67 offen lds
  v_lshl_add_u32 v10, v2, 4, v9
  v_lshl_add_u32 v35, v10, 3, s55
  s_lshl_b32 s55, s48, 2
  s_add_u32 s55, s55, s51
  s_lshl_b32 s55, s55, 4
  s_lshl_b32 s56, s49, 1
  s_mul_i32 s64, s67, 1344
  s_add_u32 m0, s54, 34816
  s_nop 0
  buffer_load_dwordx4 v40, s[12:15], s64 offen offset:0 lds
  s_add_u32 s55, s55, s56
  s_add_u32 s55, s55, s52
  s_lshl_b32 s98, s55, 10
  s_lshl_b32 s55, s48, 7
  s_lshl_b32 s56, s49, 2
  s_add_u32 s55, s55, s56
  s_add_u32 m0, s54, 35840
  s_nop 0
  buffer_load_dwordx4 v41, s[12:15], s64 offen offset:0 lds
  s_add_u32 s99, s55, 16777216
  s_mul_i32 s84, s46, 37
  s_lshr_b32 s84, s84, 8
  s_mul_i32 s85, s84, 7
  s_sub_u32 s85, s46, s85
  s_lshr_b32 s55, s45, 1
  s_add_u32 m0, s54, 42112
  s_nop 0
  buffer_load_dwordx4 v40, s[12:15], s64 offen offset:896 lds
  s_lshl_b32 s55, s55, 2
  s_add_u32 s86, s84, s55
  s_and_b32 s55, s45, 1
  s_mul_i32 s55, s55, 7
  s_add_u32 s87, s85, s55
  s_waitcnt lgkmcnt(2)
  v_dot2c_f32_bf16 v48, v84, v20
  s_add_u32 m0, s54, 43136
  s_nop 0
  buffer_load_dwordx4 v41, s[12:15], s64 offen offset:896 lds
  v_dot2c_f32_bf16 v49, v84, v84
  s_waitcnt lgkmcnt(1)
  v_dot2c_f32_bf16 v50, v88, v20
  v_dot2c_f32_bf16 v51, v88, v88
  s_waitcnt lgkmcnt(0)
  v_dot2c_f32_bf16 v52, v92, v20
  v_dot2c_f32_bf16 v53, v92, v92
  v_dot2c_f32_bf16 v48, v85, v20
  s_add_u32 m0, s54, 49408
  s_nop 0
  buffer_load_dwordx4 v40, s[12:15], s64 offen offset:1792 lds
  v_dot2c_f32_bf16 v49, v85, v85
  v_dot2c_f32_bf16 v50, v89, v20
  v_dot2c_f32_bf16 v51, v89, v89
  v_dot2c_f32_bf16 v52, v93, v20
  v_dot2c_f32_bf16 v53, v93, v93
  v_dot2c_f32_bf16 v48, v86, v20
  s_add_u32 m0, s54, 50432
  s_nop 0
  buffer_load_dwordx4 v41, s[12:15], s64 offen offset:1792 lds
  v_dot2c_f32_bf16 v49, v86, v86
  v_dot2c_f32_bf16 v50, v90, v20
  v_dot2c_f32_bf16 v51, v90, v90
  v_dot2c_f32_bf16 v52, v94, v20
  v_dot2c_f32_bf16 v53, v94, v94
  v_dot2c_f32_bf16 v48, v87, v20
  v_dot2c_f32_bf16 v49, v87, v87
  v_dot2c_f32_bf16 v50, v91, v20
  v_dot2c_f32_bf16 v51, v91, v91
  v_dot2c_f32_bf16 v52, v95, v20
  v_dot2c_f32_bf16 v53, v95, v95
  s_waitcnt vmcnt(9)
  s_barrier
  s_waitcnt vmcnt(6)
  ds_read_b128 v[84:87], v54 offset:34816
  ds_read_b128 v[88:91], v54 offset:35840
  ds_read_b128 v[92:95], v56 offset:34816
  s_add_u32 s67, s67, 128
  s_cmp_eq_u32 s67, 896
  s_cselect_b32 s67, 0, s67
  s_add_u32 m0, s65, 102400
  s_mov_b64 exec, s[58:59]
  buffer_load_dwordx4 v44, s[8:11], s67 offen lds
  s_mov_b64 exec, -1
  s_add_u32 m0, s54, 94208
  s_nop 0
  buffer_load_dwordx4 v42, s[8:11], s67 offen lds
  s_lshl_b32 s55, s45, 2
  s_add_u32 s84, s84, s55
  s_bfe_u32 s55, s44, 0x10001
  s_lshl_b32 s55, s55, 3
  v_lshl_or_b32 v8, v2, 1, s55
  v_xor_b32 v8, v8, v3
  s_add_u32 m0, s54, 95232
  s_nop 0
  buffer_load_dwordx4 v43, s[8:11], s67 offen lds
  s_lshl_b32 s55, s44, 2
  v_add_u32 v9, s55, v2
  v_mul_u32_u24 v9, 3584, v9
  v_lshl_add_u32 v9, v8, 4, v9
  s_lshl_b32 s55, s87, 8
  v_add_u32 v16, s55, v9
  s_mul_i32 s64, s67, 1344
  s_add_u32 m0, s54, 69632
  s_nop 0
  buffer_load_dwordx4 v40, s[12:15], s64 offen offset:0 lds
  v_lshl_add_u32 v8, v2, 2, v4
  v_and_b32 v9, 6, v8
  s_mul_i32 s55, s52, 224
  v_add_u32 v8, s55, v8
  v_lshlrev_b32 v8, 7, v8
  v_lshrrev_b32 v10, 1, v5
  s_add_u32 m0, s54, 70656
  s_nop 0
  buffer_load_dwordx4 v41, s[12:15], s64 offen offset:0 lds
  s_lshl_b32 s55, s52, 2
  v_or_b32 v10, s55, v10
  v_xor_b32 v10, v10, v9
  v_lshl_add_u32 v8, v10, 4, v8
  v_and_b32 v9, 1, v5
  v_lshl_add_u32 v28, v9, 3, v8
  s_add_u32 m0, s54, 76928
  s_nop 0
  buffer_load_dwordx4 v40, s[12:15], s64 offen offset:896 lds
  v_xor_b32 v29, 64, v28
  v_mov_b32 v9, 2048
  v_cndmask_b32 v9, 0, v9, s[94:95]
  v_add_u32 v30, v28, v9
  v_add_u32 v31, v29, v9
  s_waitcnt lgkmcnt(2)
  v_dot2c_f32_bf16 v48, v84, v20
  v_dot2c_f32_bf16 v49, v84, v84
  s_add_u32 m0, s54, 77952
  s_nop 0
  buffer_load_dwordx4 v41, s[12:15], s64 offen offset:896 lds
  s_waitcnt lgkmcnt(1)
  v_dot2c_f32_bf16 v50, v88, v20
  v_dot2c_f32_bf16 v51, v88, v88
  s_waitcnt lgkmcnt(0)
  v_dot2c_f32_bf16 v52, v92, v20
  v_dot2c_f32_bf16 v53, v92, v92
  v_dot2c_f32_bf16 v48, v85, v20
  v_dot2c_f32_bf16 v49, v85, v85
  s_add_u32 m0, s54, 84224
  s_nop 0
  buffer_load_dwordx4 v40, s[12:15], s64 offen offset:1792 lds
  v_dot2c_f32_bf16 v50, v89, v20
  v_dot2c_f32_bf16 v51, v89, v89
  v_dot2c_f32_bf16 v52, v93, v20
  v_dot2c_f32_bf16 v53, v93, v93
  v_dot2c_f32_bf16 v48, v86, v20
  v_dot2c_f32_bf16 v49, v86, v86
  s_add_u32 m0, s54, 85248
  s_nop 0
  buffer_load_dwordx4 v41, s[12:15], s64 offen offset:1792 lds
  v_dot2c_f32_bf16 v50, v90, v20
  v_dot2c_f32_bf16 v51, v90, v90
  v_dot2c_f32_bf16 v52, v94, v20
  v_dot2c_f32_bf16 v53, v94, v94
  v_dot2c_f32_bf16 v48, v87, v20
  v_dot2c_f32_bf16 v49, v87, v87
  v_dot2c_f32_bf16 v50, v91, v20
  v_dot2c_f32_bf16 v51, v91, v91
  v_dot2c_f32_bf16 v52, v95, v20
  v_dot2c_f32_bf16 v53, v95, v95
  v_and_b32 v8, 6, v12
  v_xor_b32 v8, v8, v13
  s_lshl_b32 s55, s51, 3
  v_add_u32 v9, s55, v12
  v_mul_u32_u24 v9, 896, v9
  v_lshl_add_u32 v9, v8, 4, v9
  s_lshl_b32 s55, s85, 7
  v_add_u32 v45, s55, v9
  s_lshl_b32 s66, s51, 10
  s_lshl_b32 s55, s51, 6
  s_add_u32 s55, s55, 139264
  v_lshl_add_u32 v46, v12, 2, s55
  s_lshl_b32 s55, s51, 4
  s_add_u32 s55, s55, 139520
  v_lshl_add_u32 v47, v12, 2, s55
  v_mov_b32 v6, 0
  buffer_load_dword v17, v6, s[40:43], 0 offen sc1
  s_waitcnt vmcnt(10)
  s_barrier
  s_waitcnt vmcnt(7)
  ds_read_b128 v[84:87], v55 offset:0
  ds_read_b128 v[88:91], v55 offset:1024
  ds_read_b128 v[92:95], v57 offset:0
  s_add_u32 s67, s67, 128
  s_cmp_eq_u32 s67, 896
  s_cselect_b32 s67, 0, s67
  s_add_u32 m0, s65, 137216
  s_mov_b64 exec, s[58:59]
  buffer_load_dwordx4 v44, s[8:11], s67 offen lds
  s_mov_b64 exec, -1
  s_add_u32 m0, s54, 129024
  s_nop 0
  buffer_load_dwordx4 v42, s[8:11], s67 offen lds
  s_waitcnt lgkmcnt(2)
  v_dot2c_f32_bf16 v48, v84, v20
  v_dot2c_f32_bf16 v49, v84, v84
  s_waitcnt lgkmcnt(1)
  v_dot2c_f32_bf16 v50, v88, v20
  s_add_u32 m0, s54, 130048
  s_nop 0
  buffer_load_dwordx4 v43, s[8:11], s67 offen lds
  v_dot2c_f32_bf16 v51, v88, v88
  s_waitcnt lgkmcnt(0)
  v_dot2c_f32_bf16 v52, v92, v20
  v_dot2c_f32_bf16 v53, v92, v92
  s_mul_i32 s64, s67, 1344
  s_add_u32 m0, s54, 104448
  s_nop 0
  buffer_load_dwordx4 v40, s[12:15], s64 offen offset:0 lds
  v_dot2c_f32_bf16 v48, v85, v20
  v_dot2c_f32_bf16 v49, v85, v85
  v_dot2c_f32_bf16 v50, v89, v20
  s_add_u32 m0, s54, 105472
  s_nop 0
  buffer_load_dwordx4 v41, s[12:15], s64 offen offset:0 lds
  v_dot2c_f32_bf16 v51, v89, v89
  v_dot2c_f32_bf16 v52, v93, v20
  v_dot2c_f32_bf16 v53, v93, v93
  s_add_u32 m0, s54, 111744
  s_nop 0
  buffer_load_dwordx4 v40, s[12:15], s64 offen offset:896 lds
  v_dot2c_f32_bf16 v48, v86, v20
  v_dot2c_f32_bf16 v49, v86, v86
  v_dot2c_f32_bf16 v50, v90, v20
  s_add_u32 m0, s54, 112768
  s_nop 0
  buffer_load_dwordx4 v41, s[12:15], s64 offen offset:896 lds
  v_dot2c_f32_bf16 v51, v90, v90
  v_dot2c_f32_bf16 v52, v94, v20
  v_dot2c_f32_bf16 v53, v94, v94
  s_add_u32 m0, s54, 119040
  s_nop 0
  buffer_load_dwordx4 v40, s[12:15], s64 offen offset:1792 lds
  v_dot2c_f32_bf16 v48, v87, v20
  v_dot2c_f32_bf16 v49, v87, v87
  v_dot2c_f32_bf16 v50, v91, v20
  s_add_u32 m0, s54, 120064
  s_nop 0
  buffer_load_dwordx4 v41, s[12:15], s64 offen offset:1792 lds
  v_dot2c_f32_bf16 v51, v91, v91
  v_dot2c_f32_bf16 v52, v95, v20
  v_dot2c_f32_bf16 v53, v95, v95
  s_waitcnt vmcnt(10)
  s_barrier
  s_waitcnt vmcnt(6)
  ds_read_b128 v[84:87], v55 offset:34816
  ds_read_b128 v[88:91], v55 offset:35840
  ds_read_b128 v[92:95], v57 offset:34816
  s_add_u32 m0, s66, 0
  s_mov_b32 s64, 0
  buffer_load_dwordx4 v45, s[16:19], s64 offen lds
  s_add_u32 m0, s66, 4096
  s_mov_b32 s64, 28672
  buffer_load_dwordx4 v45, s[16:19], s64 offen lds
  s_add_u32 m0, s66, 8192
  s_mov_b32 s64, 57344
  buffer_load_dwordx4 v45, s[16:19], s64 offen lds
  s_waitcnt lgkmcnt(2)
  v_dot2c_f32_bf16 v48, v84, v20
  v_dot2c_f32_bf16 v49, v84, v84
  s_waitcnt lgkmcnt(1)
  v_dot2c_f32_bf16 v50, v88, v20
  v_dot2c_f32_bf16 v51, v88, v88
  s_waitcnt lgkmcnt(0)
  v_dot2c_f32_bf16 v52, v92, v20
  v_dot2c_f32_bf16 v53, v92, v92
  v_dot2c_f32_bf16 v48, v85, v20
  v_dot2c_f32_bf16 v49, v85, v85
  v_dot2c_f32_bf16 v50, v89, v20
  v_dot2c_f32_bf16 v51, v89, v89
  v_dot2c_f32_bf16 v52, v93, v20
  v_dot2c_f32_bf16 v53, v93, v93
  v_dot2c_f32_bf16 v48, v86, v20
  v_dot2c_f32_bf16 v49, v86, v86
  v_dot2c_f32_bf16 v50, v90, v20
  v_dot2c_f32_bf16 v51, v90, v90
  v_dot2c_f32_bf16 v52, v94, v20
  v_dot2c_f32_bf16 v53, v94, v94
  v_dot2c_f32_bf16 v48, v87, v20
  v_dot2c_f32_bf16 v49, v87, v87
  v_dot2c_f32_bf16 v50, v91, v20
  v_dot2c_f32_bf16 v51, v91, v91
  v_dot2c_f32_bf16 v52, v95, v20
  v_dot2c_f32_bf16 v53, v95, v95
  s_nop 2
  v_add_f32_dpp v48, v48, v48 quad_perm:[1,0,3,2] row_mask:0xf bank_mask:0xf
  v_add_f32_dpp v49, v49, v49 quad_perm:[1,0,3,2] row_mask:0xf bank_mask:0xf
  v_add_f32_dpp v50, v50, v50 quad_perm:[1,0,3,2] row_mask:0xf bank_mask:0xf
  v_add_f32_dpp v51, v51, v51 quad_perm:[1,0,3,2] row_mask:0xf bank_mask:0xf
  v_add_f32_dpp v52, v52, v52 quad_perm:[1,0,3,2] row_mask:0xf bank_mask:0xf
  v_add_f32_dpp v53, v53, v53 quad_perm:[1,0,3,2] row_mask:0xf bank_mask:0xf
  v_add_f32_dpp v48, v48, v48 quad_perm:[2,3,0,1] row_mask:0xf bank_mask:0xf
  v_add_f32_dpp v49, v49, v49 quad_perm:[2,3,0,1] row_mask:0xf bank_mask:0xf
  v_add_f32_dpp v50, v50, v50 quad_perm:[2,3,0,1] row_mask:0xf bank_mask:0xf
  v_add_f32_dpp v51, v51, v51 quad_perm:[2,3,0,1] row_mask:0xf bank_mask:0xf
  v_add_f32_dpp v52, v52, v52 quad_perm:[2,3,0,1] row_mask:0xf bank_mask:0xf
  v_add_f32_dpp v53, v53, v53 quad_perm:[2,3,0,1] row_mask:0xf bank_mask:0xf
  v_add_f32_dpp v48, v48, v48 row_half_mirror row_mask:0xf bank_mask:0xf
  v_add_f32_dpp v49, v49, v49 row_half_mirror row_mask:0xf bank_mask:0xf
  v_add_f32_dpp v50, v50, v50 row_half_mirror row_mask:0xf bank_mask:0xf
  v_add_f32_dpp v51, v51, v51 row_half_mirror row_mask:0xf bank_mask:0xf
  v_add_f32_dpp v52, v52, v52 row_half_mirror row_mask:0xf bank_mask:0xf
  v_add_f32_dpp v53, v53, v53 row_half_mirror row_mask:0xf bank_mask:0xf
  s_mov_b32 s55, 0x3b124925
  v_mov_b32 v8, 0x3727c5ac
  v_mul_f32 v48, -s55, v48
  v_fma_f32 v49, v49, s55, v8
  v_mul_f32 v50, -s55, v50
  v_fma_f32 v51, v51, s55, v8
  v_mul_f32 v52, -s55, v52
  v_fma_f32 v53, v53, s55, v8
  v_fma_f32 v49, -v48, v48, v49
  v_fma_f32 v51, -v50, v50, v51
  v_fma_f32 v53, -v52, v52, v53
  v_max_f32 v49, v49, v8
  v_max_f32 v51, v51, v8
  v_max_f32 v53, v53, v8
  v_rsq_f32 v49, v49
  v_rsq_f32 v51, v51
  v_rsq_f32 v53, v53
  ds_write_b32 v46, v48
  ds_write_b32 v46, v50 offset:32
  ds_write_b32 v46, v49 offset:384
  ds_write_b32 v46, v51 offset:416
  s_mov_b32 exec_hi, 0
  ds_write_b32 v47, v52
  ds_write_b32 v47, v53 offset:384
  s_mov_b64 exec, -1
  s_waitcnt vmcnt(3) lgkmcnt(0)
  s_barrier
  ds_read_b32 v39, v36
  ds_read_b128 v[120:123], v37
  ds_read_b128 v[124:127], v38
  s_add_u32 m0, s66, 12288
  s_mov_b32 s64, 86016
  buffer_load_dwordx4 v45, s[16:19], s64 offen lds
  s_add_u32 m0, s66, 16384
  s_mov_b32 s64, 114688
  buffer_load_dwordx4 v45, s[16:19], s64 offen lds
  s_add_u32 m0, s66, 20480
  s_mov_b32 s64, 143360
  buffer_load_dwordx4 v45, s[16:19], s64 offen lds
  s_add_u32 m0, s66, 24576
  s_mov_b32 s64, 172032
  buffer_load_dwordx4 v45, s[16:19], s64 offen lds
  s_add_u32 m0, s66, 28672
  s_mov_b32 s64, 200704
  buffer_load_dwordx4 v45, s[16:19], s64 offen lds
  s_add_u32 m0, s66, 32768
  s_mov_b32 s64, 229376
  buffer_load_dwordx4 v45, s[16:19], s64 offen lds
  s_add_u32 m0, s66, 36864
  s_mov_b32 s64, 258048
  buffer_load_dwordx4 v45, s[16:19], s64 offen lds
  s_add_u32 m0, s66, 40960
  s_mov_b32 s64, 286720
  buffer_load_dwordx4 v45, s[16:19], s64 offen lds
  s_add_u32 m0, s66, 45056
  s_mov_b32 s64, 315392
  buffer_load_dwordx4 v45, s[16:19], s64 offen lds
  s_add_u32 m0, s66, 49152
  s_mov_b32 s64, 344064
  buffer_load_dwordx4 v45, s[16:19], s64 offen lds
  s_add_u32 m0, s66, 53248
  s_mov_b32 s64, 372736
  buffer_load_dwordx4 v45, s[16:19], s64 offen lds
  s_waitcnt vmcnt(0) lgkmcnt(0)
  s_setprio 0
  s_branch LAjoin
LAcons:
  s_waitcnt lgkmcnt(0)
  s_mov_b64 s[8:9], s[64:65]
  s_mov_b64 s[12:13], s[66:67]
  s_mov_b64 s[16:17], s[68:69]
  s_mov_b64 s[20:21], s[72:73]
  s_mov_b64 s[24:25], s[74:75]
  s_mov_b64 s[28:29], s[76:77]
  s_mov_b64 s[32:33], s[78:79]
  s_mov_b64 s[36:37], s[82:83]
  s_mov_b64 s[40:41], s[80:81]
  s_or_b32 s3, s2, s44
  s_cmp_lg_u32 s3, 0
  s_cbranch_scc1 Lnononce
  s_or_b32 s3, s4, 1
  v_mov_b32 v8, s3
  v_mov_b32 v9, 0
  s_mov_b64 exec, 1
  buffer_store_dword v8, v9, s[40:43], 0 offen sc1
  s_mov_b64 exec, -1
Lnononce:
  s_and_b32 s66, s44, 1
  s_lshr_b32 s67, s44, 1
  v_bfe_u32 v8, v3, 1, 3
  v_xor_b32 v8, v8, v2
  v_lshlrev_b32 v8, 4, v8
  v_lshl_add_u32 v8, v3, 7, v8
  v_add_u32 v128, 24576, v8
  v_xor_b32 v129, 64, v128
  v_and_b32 v8, 2, v4
  v_and_b32 v9, 1, v2
  v_lshl_or_b32 v8, v9, 2, v8
  v_lshlrev_b32 v8, 4, v8
  v_lshl_add_u32 v9, v2, 3, v4
  v_lshlrev_b32 v9, 7, v9
  s_mul_i32 s68, s66, 3
  s_mul_i32 s56, s67, 56
  s_add_u32 s57, s68, 0
  s_and_b32 s55, s57, 1
  s_lshl_b32 s55, s55, 5
  s_add_u32 s55, s55, s56
  v_lshl_add_u32 v10, v5, 3, s55
  v_xor_b32 v10, v10, v8
  s_lshr_b32 s55, s57, 1
  s_lshl_b32 s55, s55, 13
  v_add3_u32 v130, v10, v9, s55
  s_add_u32 s57, s68, 1
  s_and_b32 s55, s57, 1
  s_lshl_b32 s55, s55, 5
  s_add_u32 s55, s55, s56
  v_lshl_add_u32 v10, v5, 3, s55
  v_xor_b32 v10, v10, v8
  s_lshr_b32 s55, s57, 1
  s_lshl_b32 s55, s55, 13
  v_add3_u32 v131, v10, v9, s55
  s_add_u32 s57, s68, 2
  s_and_b32 s55, s57, 1
  s_lshl_b32 s55, s55, 5
  s_add_u32 s55, s55, s56
  v_lshl_add_u32 v10, v5, 3, s55
  v_xor_b32 v10, v10, v8
  s_lshr_b32 s55, s57, 1
  s_lshl_b32 s55, s55, 13
  v_add3_u32 v132, v10, v9, s55
  v_add_u32 v133, 69632, v128
  v_add_u32 v134, 69632, v129
  v_add_u32 v135, 69632, v130
  v_add_u32 v136, 69632, v131
  v_add_u32 v137, 69632, v132
  s_mul_i32 s55, s44, 1536
  s_add_u32 s55, s55, 69632
  v_lshl_add_u32 v138, v1, 3, s55
  v_lshlrev_b32 v139, 2, v3
  v_add_u32 v139, 139264, v139
  v_lshlrev_b32 v8, 2, v2
  v_sub_u32 v9, v3, v8
  s_lshl_b32 s55, s48, 2
  s_add_u32 s55, s55, s51
  s_cmp_lt_u32 s55, 2
  s_cselect_b32 s56, 0x10000, 0
  v_mov_b32 v11, 0xff800000
  v_subrev_u32 v10, 0, v9
  v_cmp_gt_u32 vcc, 8, v10
  s_nop 1
  v_cndmask_b32 v80, v11, 0, vcc
  v_add_u32 v10, 16, v10
  v_add_u32 v10, s56, v10
  v_cmp_gt_u32 vcc, 8, v10
  s_nop 1
  v_cndmask_b32 v76, v11, 0, vcc
  v_subrev_u32 v10, 1, v9
  v_cmp_gt_u32 vcc, 8, v10
  s_nop 1
  v_cndmask_b32 v81, v11, 0, vcc
  v_add_u32 v10, 16, v10
  v_add_u32 v10, s56, v10
  v_cmp_gt_u32 vcc, 8, v10
  s_nop 1
  v_cndmask_b32 v77, v11, 0, vcc
  v_subrev_u32 v10, 2, v9
  v_cmp_gt_u32 vcc, 8, v10
  s_nop 1
  v_cndmask_b32 v82, v11, 0, vcc
  v_add_u32 v10, 16, v10
  v_add_u32 v10, s56, v10
  v_cmp_gt_u32 vcc, 8, v10
  s_nop 1
  v_cndmask_b32 v78, v11, 0, vcc
  v_subrev_u32 v10, 3, v9
  v_cmp_gt_u32 vcc, 8, v10
  s_nop 1
  v_cndmask_b32 v83, v11, 0, vcc
  v_add_u32 v10, 16, v10
  v_add_u32 v10, s56, v10
  v_cmp_gt_u32 vcc, 8, v10
  s_nop 1
  v_cndmask_b32 v79, v11, 0, vcc
  v_cmp_gt_u32 s[94:95], 3, v2
  s_mul_i32 s56, s52, 3072
  s_add_u32 s56, s56, 69632
  s_mul_i32 s55, s51, 6144
  s_add_u32 s55, s55, s56
  v_lshl_add_u32 v32, v1, 3, s55
  v_lshl_add_u32 v9, v2, 2, v4
  v_lshl_add_u32 v10, v5, 4, v9
  v_lshl_add_u32 v33, v10, 3, s55
  s_sub_u32 s55, s55, 12288
  s_add_u32 s56, s56, 24576
  s_lshl_b32 s97, s51, 3
  s_lshl_b32 s57, s51, 6
  s_add_u32 s57, s57, 139648
  v_lshl_add_u32 v36, v3, 2, s57
  v_lshl_add_u32 v37, v2, 4, s57
  s_sub_u32 s57, s57, 128
  s_cmp_lt_u32 s51, 2
  s_cselect_b32 s96, 7, 15
  s_cselect_b32 s97, s97, 0
  s_cselect_b32 s55, s56, s55
  s_cselect_b32 s57, 139904, s57
  v_and_b32 v9, s96, v9
  v_add_u32 v9, s97, v9
  v_lshl_add_u32 v10, v5, 4, v9
  v_lshl_add_u32 v34, v10, 3, s55
  v_and_b32 v9, s96, v8
  v_add_u32 v9, s97, v9
  v_lshl_add_u32 v38, v9, 2, s57
  v_and_b32 v9, s96, v3
  v_add_u32 v9, s97, v9
  v_lshl_add_u32 v10, v2, 4, v9
  v_lshl_add_u32 v35, v10, 3, s55
  s_lshl_b32 s55, s48, 2
  s_add_u32 s55, s55, s51
  s_lshl_b32 s55, s55, 4
  s_lshl_b32 s56, s49, 1
  s_add_u32 s55, s55, s56
  s_add_u32 s55, s55, s52
  s_lshl_b32 s98, s55, 10
  s_lshl_b32 s55, s48, 7
  s_lshl_b32 s56, s49, 2
  s_add_u32 s55, s55, s56
  s_add_u32 s99, s55, 16777216
  s_mul_i32 s84, s46, 37
  s_lshr_b32 s84, s84, 8
  s_mul_i32 s85, s84, 7
  s_sub_u32 s85, s46, s85
  s_lshr_b32 s55, s45, 1
  s_lshl_b32 s55, s55, 2
  s_add_u32 s86, s84, s55
  s_and_b32 s55, s45, 1
  s_mul_i32 s55, s55, 7
  s_add_u32 s87, s85, s55
  s_lshl_b32 s55, s45, 2
  s_add_u32 s84, s84, s55
  s_bfe_u32 s55, s44, 0x10001
  s_lshl_b32 s55, s55, 3
  v_lshl_or_b32 v8, v2, 1, s55
  v_xor_b32 v8, v8, v3
  s_lshl_b32 s55, s44, 2
  v_add_u32 v9, s55, v2
  v_mul_u32_u24 v9, 3584, v9
  v_lshl_add_u32 v9, v8, 4, v9
  s_lshl_b32 s55, s87, 8
  v_add_u32 v16, s55, v9
  v_lshl_add_u32 v8, v2, 2, v4
  v_and_b32 v9, 6, v8
  s_mul_i32 s55, s52, 224
  v_add_u32 v8, s55, v8
  v_lshlrev_b32 v8, 7, v8
  v_lshrrev_b32 v10, 1, v5
  s_lshl_b32 s55, s52, 2
  v_or_b32 v10, s55, v10
  v_xor_b32 v10, v10, v9
  v_lshl_add_u32 v8, v10, 4, v8
  v_and_b32 v9, 1, v5
  v_lshl_add_u32 v28, v9, 3, v8
  v_xor_b32 v29, 64, v28
  v_mov_b32 v9, 2048
  v_cndmask_b32 v9, 0, v9, s[94:95]
  v_add_u32 v30, v28, v9
  v_add_u32 v31, v29, v9
  s_cmp_lg_u32 s44, 2
  s_cbranch_scc1 Ltn_2
  s_mul_i32 s3, s2, 4736
  v_min_u32 v6, 36, v1
  v_lshlrev_b32 v6, 7, v6
  buffer_load_dword v7, v6, s[12:15], s3 offen
  s_branch Ltend_1
Ltn_2:
  s_cmp_lg_u32 s44, 3
  s_cbranch_scc1 Ltn_3
  s_mul_i32 s3, s2, 7168
  v_min_u32 v6, 55, v1
  v_lshlrev_b32 v6, 7, v6
  buffer_load_dword v7, v6, s[8:11], s3 offen
  s_branch Ltend_1
Ltn_3:
Ltend_1:
  s_waitcnt lgkmcnt(0)
  s_barrier
  ds_read_b64_tr_b16 v[60:61], v130 offset:34816
  ds_read_b64_tr_b16 v[62:63], v130 offset:35328
  ds_read_b128 v[56:59], v128 offset:43008
  ds_read_b128 v[40:43], v128 offset:34816
  ds_read_b128 v[44:47], v128 offset:36864
  ds_read_b128 v[48:51], v128 offset:38912
  ds_read_b128 v[52:55], v128 offset:40960
  ds_read_b64_tr_b16 v[64:65], v131 offset:34816
  ds_read_b64_tr_b16 v[66:67], v131 offset:35328
  ds_read_b64_tr_b16 v[68:69], v132 offset:34816
  ds_read_b64_tr_b16 v[70:71], v132 offset:35328
  s_waitcnt lgkmcnt(8)
  v_mfma_f32_16x16x32_bf16 v[156:159], v[60:63], v[56:59], 0
  ds_read_b64_tr_b16 v[104:105], v130 offset:38912
  s_waitcnt lgkmcnt(8)
  v_mfma_f32_16x16x32_bf16 v[140:143], v[60:63], v[40:43], 0
  ds_read_b64_tr_b16 v[106:107], v130 offset:39424
  s_waitcnt lgkmcnt(8)
  v_mfma_f32_16x16x32_bf16 v[144:147], v[60:63], v[44:47], 0
  ds_read_b128 v[100:103], v129 offset:43008
  s_waitcnt lgkmcnt(8)
  v_mfma_f32_16x16x32_bf16 v[148:151], v[60:63], v[48:51], 0
  ds_read_b128 v[84:87], v129 offset:34816
  s_waitcnt lgkmcnt(8)
  v_mfma_f32_16x16x32_bf16 v[152:155], v[60:63], v[52:55], 0
  ds_read_b128 v[88:91], v129 offset:36864
  s_waitcnt lgkmcnt(7)
  v_mfma_f32_16x16x32_bf16 v[176:179], v[64:67], v[56:59], 0
  ds_read_b128 v[92:95], v129 offset:38912
  v_mfma_f32_16x16x32_bf16 v[160:163], v[64:67], v[40:43], 0
  ds_read_b128 v[96:99], v129 offset:40960
  v_mfma_f32_16x16x32_bf16 v[164:167], v[64:67], v[44:47], 0
  ds_read_b64_tr_b16 v[108:109], v131 offset:38912
  v_mfma_f32_16x16x32_bf16 v[168:171], v[64:67], v[48:51], 0
  ds_read_b64_tr_b16 v[110:111], v131 offset:39424
  v_mfma_f32_16x16x32_bf16 v[172:175], v[64:67], v[52:55], 0
  ds_read_b64_tr_b16 v[112:113], v132 offset:38912
  s_waitcnt lgkmcnt(10)
  v_mfma_f32_16x16x32_bf16 v[196:199], v[68:71], v[56:59], 0
  ds_read_b64_tr_b16 v[114:115], v132 offset:39424
  v_mfma_f32_16x16x32_bf16 v[180:183], v[68:71], v[40:43], 0
  v_mfma_f32_16x16x32_bf16 v[184:187], v[68:71], v[44:47], 0
  v_mfma_f32_16x16x32_bf16 v[188:191], v[68:71], v[48:51], 0
  v_mfma_f32_16x16x32_bf16 v[192:195], v[68:71], v[52:55], 0
  s_waitcnt lgkmcnt(8)
  v_mfma_f32_16x16x32_bf16 v[156:159], v[104:107], v[100:103], v[156:159]
  s_waitcnt lgkmcnt(7)
  v_mfma_f32_16x16x32_bf16 v[140:143], v[104:107], v[84:87], v[140:143]
  s_waitcnt lgkmcnt(6)
  v_mfma_f32_16x16x32_bf16 v[144:147], v[104:107], v[88:91], v[144:147]
  s_waitcnt lgkmcnt(5)
  v_mfma_f32_16x16x32_bf16 v[148:151], v[104:107], v[92:95], v[148:151]
  s_waitcnt lgkmcnt(4)
  v_mfma_f32_16x16x32_bf16 v[152:155], v[104:107], v[96:99], v[152:155]
  s_waitcnt lgkmcnt(2)
  v_mfma_f32_16x16x32_bf16 v[176:179], v[108:111], v[100:103], v[176:179]
  v_mfma_f32_16x16x32_bf16 v[160:163], v[108:111], v[84:87], v[160:163]
  v_mfma_f32_16x16x32_bf16 v[164:167], v[108:111], v[88:91], v[164:167]
  v_mfma_f32_16x16x32_bf16 v[168:171], v[108:111], v[92:95], v[168:171]
  v_mfma_f32_16x16x32_bf16 v[172:175], v[108:111], v[96:99], v[172:175]
  s_waitcnt lgkmcnt(0)
  v_mfma_f32_16x16x32_bf16 v[196:199], v[112:115], v[100:103], v[196:199]
  v_mfma_f32_16x16x32_bf16 v[180:183], v[112:115], v[84:87], v[180:183]
  v_mfma_f32_16x16x32_bf16 v[184:187], v[112:115], v[88:91], v[184:187]
  v_mfma_f32_16x16x32_bf16 v[188:191], v[112:115], v[92:95], v[188:191]
  v_mfma_f32_16x16x32_bf16 v[192:195], v[112:115], v[96:99], v[192:195]
  s_waitcnt lgkmcnt(0)
  s_barrier
  ds_read_b64_tr_b16 v[60:61], v135 offset:0
  ds_read_b64_tr_b16 v[62:63], v135 offset:512
  ds_read_b128 v[56:59], v133 offset:8192
  ds_read_b128 v[40:43], v133 offset:0
  ds_read_b128 v[44:47], v133 offset:2048
  ds_read_b128 v[48:51], v133 offset:4096
  ds_read_b128 v[52:55], v133 offset:6144
  ds_read_b64_tr_b16 v[64:65], v136 offset:0
  ds_read_b64_tr_b16 v[66:67], v136 offset:512
  ds_read_b64_tr_b16 v[68:69], v137 offset:0
  ds_read_b64_tr_b16 v[70:71], v137 offset:512
  s_waitcnt lgkmcnt(8)
  v_mfma_f32_16x16x32_bf16 v[156:159], v[60:63], v[56:59], v[156:159]
  ds_read_b64_tr_b16 v[104:105], v135 offset:4096
  s_waitcnt lgkmcnt(8)
  v_mfma_f32_16x16x32_bf16 v[140:143], v[60:63], v[40:43], v[140:143]
  ds_read_b64_tr_b16 v[106:107], v135 offset:4608
  s_waitcnt lgkmcnt(8)
  v_mfma_f32_16x16x32_bf16 v[144:147], v[60:63], v[44:47], v[144:147]
  ds_read_b128 v[100:103], v134 offset:8192
  s_waitcnt lgkmcnt(8)
  v_mfma_f32_16x16x32_bf16 v[148:151], v[60:63], v[48:51], v[148:151]
  ds_read_b128 v[84:87], v134 offset:0
  s_waitcnt lgkmcnt(8)
  v_mfma_f32_16x16x32_bf16 v[152:155], v[60:63], v[52:55], v[152:155]
  ds_read_b128 v[88:91], v134 offset:2048
  s_waitcnt lgkmcnt(7)
  v_mfma_f32_16x16x32_bf16 v[176:179], v[64:67], v[56:59], v[176:179]
  ds_read_b128 v[92:95], v134 offset:4096
  v_mfma_f32_16x16x32_bf16 v[160:163], v[64:67], v[40:43], v[160:163]
  ds_read_b128 v[96:99], v134 offset:6144
  v_mfma_f32_16x16x32_bf16 v[164:167], v[64:67], v[44:47], v[164:167]
  ds_read_b64_tr_b16 v[108:109], v136 offset:4096
  v_mfma_f32_16x16x32_bf16 v[168:171], v[64:67], v[48:51], v[168:171]
  ds_read_b64_tr_b16 v[110:111], v136 offset:4608
  v_mfma_f32_16x16x32_bf16 v[172:175], v[64:67], v[52:55], v[172:175]
  ds_read_b64_tr_b16 v[112:113], v137 offset:4096
  s_waitcnt lgkmcnt(10)
  v_mfma_f32_16x16x32_bf16 v[196:199], v[68:71], v[56:59], v[196:199]
  ds_read_b64_tr_b16 v[114:115], v137 offset:4608
  v_mfma_f32_16x16x32_bf16 v[180:183], v[68:71], v[40:43], v[180:183]
  v_mfma_f32_16x16x32_bf16 v[184:187], v[68:71], v[44:47], v[184:187]
  v_mfma_f32_16x16x32_bf16 v[188:191], v[68:71], v[48:51], v[188:191]
  v_mfma_f32_16x16x32_bf16 v[192:195], v[68:71], v[52:55], v[192:195]
  s_waitcnt lgkmcnt(8)
  v_mfma_f32_16x16x32_bf16 v[156:159], v[104:107], v[100:103], v[156:159]
  s_waitcnt lgkmcnt(7)
  v_mfma_f32_16x16x32_bf16 v[140:143], v[104:107], v[84:87], v[140:143]
  s_waitcnt lgkmcnt(6)
  v_mfma_f32_16x16x32_bf16 v[144:147], v[104:107], v[88:91], v[144:147]
  s_waitcnt lgkmcnt(5)
  v_mfma_f32_16x16x32_bf16 v[148:151], v[104:107], v[92:95], v[148:151]
  s_waitcnt lgkmcnt(4)
  v_mfma_f32_16x16x32_bf16 v[152:155], v[104:107], v[96:99], v[152:155]
  s_waitcnt lgkmcnt(2)
  v_mfma_f32_16x16x32_bf16 v[176:179], v[108:111], v[100:103], v[176:179]
  v_mfma_f32_16x16x32_bf16 v[160:163], v[108:111], v[84:87], v[160:163]
  v_mfma_f32_16x16x32_bf16 v[164:167], v[108:111], v[88:91], v[164:167]
  v_mfma_f32_16x16x32_bf16 v[168:171], v[108:111], v[92:95], v[168:171]
  v_mfma_f32_16x16x32_bf16 v[172:175], v[108:111], v[96:99], v[172:175]
  s_waitcnt lgkmcnt(0)
  v_mfma_f32_16x16x32_bf16 v[196:199], v[112:115], v[100:103], v[196:199]
  v_mfma_f32_16x16x32_bf16 v[180:183], v[112:115], v[84:87], v[180:183]
  v_mfma_f32_16x16x32_bf16 v[184:187], v[112:115], v[88:91], v[184:187]
  v_mfma_f32_16x16x32_bf16 v[188:191], v[112:115], v[92:95], v[188:191]
  v_mfma_f32_16x16x32_bf16 v[192:195], v[112:115], v[96:99], v[192:195]
  s_waitcnt lgkmcnt(0)
  s_barrier
  ds_read_b64_tr_b16 v[60:61], v135 offset:34816
  ds_read_b64_tr_b16 v[62:63], v135 offset:35328
  ds_read_b128 v[56:59], v133 offset:43008
  ds_read_b128 v[40:43], v133 offset:34816
  ds_read_b128 v[44:47], v133 offset:36864
  ds_read_b128 v[48:51], v133 offset:38912
  ds_read_b128 v[52:55], v133 offset:40960
  ds_read_b64_tr_b16 v[64:65], v136 offset:34816
  ds_read_b64_tr_b16 v[66:67], v136 offset:35328
  ds_read_b64_tr_b16 v[68:69], v137 offset:34816
  ds_read_b64_tr_b16 v[70:71], v137 offset:35328
  s_waitcnt lgkmcnt(8)
  v_mfma_f32_16x16x32_bf16 v[156:159], v[60:63], v[56:59], v[156:159]
  ds_read_b64_tr_b16 v[104:105], v135 offset:38912
  s_waitcnt lgkmcnt(8)
  v_mfma_f32_16x16x32_bf16 v[140:143], v[60:63], v[40:43], v[140:143]
  ds_read_b64_tr_b16 v[106:107], v135 offset:39424
  s_waitcnt lgkmcnt(8)
  v_mfma_f32_16x16x32_bf16 v[144:147], v[60:63], v[44:47], v[144:147]
  ds_read_b128 v[100:103], v134 offset:43008
  s_waitcnt lgkmcnt(8)
  v_mfma_f32_16x16x32_bf16 v[148:151], v[60:63], v[48:51], v[148:151]
  ds_read_b128 v[84:87], v134 offset:34816
  s_waitcnt lgkmcnt(8)
  v_mfma_f32_16x16x32_bf16 v[152:155], v[60:63], v[52:55], v[152:155]
  ds_read_b128 v[88:91], v134 offset:36864
  s_waitcnt lgkmcnt(7)
  v_mfma_f32_16x16x32_bf16 v[176:179], v[64:67], v[56:59], v[176:179]
  ds_read_b128 v[92:95], v134 offset:38912
  v_mfma_f32_16x16x32_bf16 v[160:163], v[64:67], v[40:43], v[160:163]
  ds_read_b128 v[96:99], v134 offset:40960
  v_mfma_f32_16x16x32_bf16 v[164:167], v[64:67], v[44:47], v[164:167]
  ds_read_b64_tr_b16 v[108:109], v136 offset:38912
  v_mfma_f32_16x16x32_bf16 v[168:171], v[64:67], v[48:51], v[168:171]
  ds_read_b64_tr_b16 v[110:111], v136 offset:39424
  v_mfma_f32_16x16x32_bf16 v[172:175], v[64:67], v[52:55], v[172:175]
  ds_read_b64_tr_b16 v[112:113], v137 offset:38912
  s_waitcnt lgkmcnt(10)
  v_mfma_f32_16x16x32_bf16 v[196:199], v[68:71], v[56:59], v[196:199]
  ds_read_b64_tr_b16 v[114:115], v137 offset:39424
  v_mfma_f32_16x16x32_bf16 v[180:183], v[68:71], v[40:43], v[180:183]
  v_mfma_f32_16x16x32_bf16 v[184:187], v[68:71], v[44:47], v[184:187]
  v_mfma_f32_16x16x32_bf16 v[188:191], v[68:71], v[48:51], v[188:191]
  v_mfma_f32_16x16x32_bf16 v[192:195], v[68:71], v[52:55], v[192:195]
  s_waitcnt lgkmcnt(8)
  v_mfma_f32_16x16x32_bf16 v[156:159], v[104:107], v[100:103], v[156:159]
  s_waitcnt lgkmcnt(7)
  v_mfma_f32_16x16x32_bf16 v[140:143], v[104:107], v[84:87], v[140:143]
  s_waitcnt lgkmcnt(6)
  v_mfma_f32_16x16x32_bf16 v[144:147], v[104:107], v[88:91], v[144:147]
  s_waitcnt lgkmcnt(5)
  v_mfma_f32_16x16x32_bf16 v[148:151], v[104:107], v[92:95], v[148:151]
  s_waitcnt lgkmcnt(4)
  v_mfma_f32_16x16x32_bf16 v[152:155], v[104:107], v[96:99], v[152:155]
  s_waitcnt lgkmcnt(2)
  v_mfma_f32_16x16x32_bf16 v[176:179], v[108:111], v[100:103], v[176:179]
  v_mfma_f32_16x16x32_bf16 v[160:163], v[108:111], v[84:87], v[160:163]
  v_mfma_f32_16x16x32_bf16 v[164:167], v[108:111], v[88:91], v[164:167]
  v_mfma_f32_16x16x32_bf16 v[168:171], v[108:111], v[92:95], v[168:171]
  v_mfma_f32_16x16x32_bf16 v[172:175], v[108:111], v[96:99], v[172:175]
  s_waitcnt lgkmcnt(0)
  v_mfma_f32_16x16x32_bf16 v[196:199], v[112:115], v[100:103], v[196:199]
  v_mfma_f32_16x16x32_bf16 v[180:183], v[112:115], v[84:87], v[180:183]
  v_mfma_f32_16x16x32_bf16 v[184:187], v[112:115], v[88:91], v[184:187]
  v_mfma_f32_16x16x32_bf16 v[188:191], v[112:115], v[92:95], v[188:191]
  v_mfma_f32_16x16x32_bf16 v[192:195], v[112:115], v[96:99], v[192:195]
  s_cmp_lg_u32 s44, 0
  s_cbranch_scc1 Ltn_5
  s_mul_i32 s3, s2, 1664
  v_min_u32 v6, 12, v1
  v_lshlrev_b32 v6, 7, v6
  buffer_load_dword v7, v6, s[16:19], s3 offen
  s_branch Ltend_4
Ltn_5:
  s_cmp_lg_u32 s44, 1
  s_cbranch_scc1 Ltn_6
  s_mul_i32 s3, s2, 6272
  v_min_u32 v6, 48, v1
  v_lshlrev_b32 v6, 7, v6
  buffer_load_dword v7, v6, s[20:23], s3 offen
  s_branch Ltend_4
Ltn_6:
Ltend_4:
  s_waitcnt lgkmcnt(0)
  s_barrier
  ds_read_b64_tr_b16 v[60:61], v130 offset:0
  ds_read_b64_tr_b16 v[62:63], v130 offset:512
  ds_read_b128 v[56:59], v128 offset:8192
  ds_read_b128 v[40:43], v128 offset:0
  ds_read_b128 v[44:47], v128 offset:2048
  ds_read_b128 v[48:51], v128 offset:4096
  ds_read_b128 v[52:55], v128 offset:6144
  ds_read_b64_tr_b16 v[64:65], v131 offset:0
  ds_read_b64_tr_b16 v[66:67], v131 offset:512
  ds_read_b64_tr_b16 v[68:69], v132 offset:0
  ds_read_b64_tr_b16 v[70:71], v132 offset:512
  s_waitcnt lgkmcnt(8)
  v_mfma_f32_16x16x32_bf16 v[156:159], v[60:63], v[56:59], v[156:159]
  ds_read_b64_tr_b16 v[104:105], v130 offset:4096
  s_waitcnt lgkmcnt(8)
  v_mfma_f32_16x16x32_bf16 v[140:143], v[60:63], v[40:43], v[140:143]
  ds_read_b64_tr_b16 v[106:107], v130 offset:4608
  s_waitcnt lgkmcnt(8)
  v_mfma_f32_16x16x32_bf16 v[144:147], v[60:63], v[44:47], v[144:147]
  ds_read_b128 v[100:103], v129 offset:8192
  s_waitcnt lgkmcnt(8)
  v_mfma_f32_16x16x32_bf16 v[148:151], v[60:63], v[48:51], v[148:151]
  ds_read_b128 v[84:87], v129 offset:0
  s_waitcnt lgkmcnt(8)
  v_mfma_f32_16x16x32_bf16 v[152:155], v[60:63], v[52:55], v[152:155]
  ds_read_b128 v[88:91], v129 offset:2048
  s_waitcnt lgkmcnt(7)
  v_mfma_f32_16x16x32_bf16 v[176:179], v[64:67], v[56:59], v[176:179]
  ds_read_b128 v[92:95], v129 offset:4096
  v_mfma_f32_16x16x32_bf16 v[160:163], v[64:67], v[40:43], v[160:163]
  ds_read_b128 v[96:99], v129 offset:6144
  v_mfma_f32_16x16x32_bf16 v[164:167], v[64:67], v[44:47], v[164:167]
  ds_read_b64_tr_b16 v[108:109], v131 offset:4096
  v_mfma_f32_16x16x32_bf16 v[168:171], v[64:67], v[48:51], v[168:171]
  ds_read_b64_tr_b16 v[110:111], v131 offset:4608
  v_mfma_f32_16x16x32_bf16 v[172:175], v[64:67], v[52:55], v[172:175]
  ds_read_b64_tr_b16 v[112:113], v132 offset:4096
  s_waitcnt lgkmcnt(10)
  v_mfma_f32_16x16x32_bf16 v[196:199], v[68:71], v[56:59], v[196:199]
  ds_read_b64_tr_b16 v[114:115], v132 offset:4608
  v_mfma_f32_16x16x32_bf16 v[180:183], v[68:71], v[40:43], v[180:183]
  v_mfma_f32_16x16x32_bf16 v[184:187], v[68:71], v[44:47], v[184:187]
  v_mfma_f32_16x16x32_bf16 v[188:191], v[68:71], v[48:51], v[188:191]
  v_mfma_f32_16x16x32_bf16 v[192:195], v[68:71], v[52:55], v[192:195]
  s_waitcnt lgkmcnt(8)
  v_mfma_f32_16x16x32_bf16 v[156:159], v[104:107], v[100:103], v[156:159]
  s_waitcnt lgkmcnt(7)
  v_mfma_f32_16x16x32_bf16 v[140:143], v[104:107], v[84:87], v[140:143]
  s_waitcnt lgkmcnt(6)
  v_mfma_f32_16x16x32_bf16 v[144:147], v[104:107], v[88:91], v[144:147]
  s_waitcnt lgkmcnt(5)
  v_mfma_f32_16x16x32_bf16 v[148:151], v[104:107], v[92:95], v[148:151]
  s_waitcnt lgkmcnt(4)
  v_mfma_f32_16x16x32_bf16 v[152:155], v[104:107], v[96:99], v[152:155]
  s_waitcnt lgkmcnt(2)
  v_mfma_f32_16x16x32_bf16 v[176:179], v[108:111], v[100:103], v[176:179]
  v_mfma_f32_16x16x32_bf16 v[160:163], v[108:111], v[84:87], v[160:163]
  v_mfma_f32_16x16x32_bf16 v[164:167], v[108:111], v[88:91], v[164:167]
  v_mfma_f32_16x16x32_bf16 v[168:171], v[108:111], v[92:95], v[168:171]
  v_mfma_f32_16x16x32_bf16 v[172:175], v[108:111], v[96:99], v[172:175]
  s_waitcnt lgkmcnt(0)
  v_mfma_f32_16x16x32_bf16 v[196:199], v[112:115], v[100:103], v[196:199]
  v_mfma_f32_16x16x32_bf16 v[180:183], v[112:115], v[84:87], v[180:183]
  v_mfma_f32_16x16x32_bf16 v[184:187], v[112:115], v[88:91], v[184:187]
  v_mfma_f32_16x16x32_bf16 v[188:191], v[112:115], v[92:95], v[188:191]
  v_mfma_f32_16x16x32_bf16 v[192:195], v[112:115], v[96:99], v[192:195]
  v_mov_b32 v6, 0
  buffer_load_dword v17, v6, s[40:43], 0 offen sc1
  s_waitcnt lgkmcnt(0)
  s_barrier
  ds_read_b64_tr_b16 v[60:61], v130 offset:34816
  ds_read_b64_tr_b16 v[62:63], v130 offset:35328
  ds_read_b128 v[56:59], v128 offset:43008
  ds_read_b128 v[40:43], v128 offset:34816
  ds_read_b128 v[44:47], v128 offset:36864
  ds_read_b128 v[48:51], v128 offset:38912
  ds_read_b128 v[52:55], v128 offset:40960
  ds_read_b64_tr_b16 v[64:65], v131 offset:34816
  ds_read_b64_tr_b16 v[66:67], v131 offset:35328
  ds_read_b64_tr_b16 v[68:69], v132 offset:34816
  ds_read_b64_tr_b16 v[70:71], v132 offset:35328
  s_waitcnt lgkmcnt(8)
  v_mfma_f32_16x16x32_bf16 v[156:159], v[60:63], v[56:59], v[156:159]
  ds_read_b64_tr_b16 v[104:105], v130 offset:38912
  s_waitcnt lgkmcnt(8)
  v_mfma_f32_16x16x32_bf16 v[140:143], v[60:63], v[40:43], v[140:143]
  ds_read_b64_tr_b16 v[106:107], v130 offset:39424
  s_waitcnt lgkmcnt(8)
  v_mfma_f32_16x16x32_bf16 v[144:147], v[60:63], v[44:47], v[144:147]
  ds_read_b128 v[100:103], v129 offset:43008
  s_waitcnt lgkmcnt(8)
  v_mfma_f32_16x16x32_bf16 v[148:151], v[60:63], v[48:51], v[148:151]
  ds_read_b128 v[84:87], v129 offset:34816
  s_waitcnt lgkmcnt(8)
  v_mfma_f32_16x16x32_bf16 v[152:155], v[60:63], v[52:55], v[152:155]
  ds_read_b128 v[88:91], v129 offset:36864
  s_waitcnt lgkmcnt(7)
  v_mfma_f32_16x16x32_bf16 v[176:179], v[64:67], v[56:59], v[176:179]
  ds_read_b128 v[92:95], v129 offset:38912
  v_mfma_f32_16x16x32_bf16 v[160:163], v[64:67], v[40:43], v[160:163]
  ds_read_b128 v[96:99], v129 offset:40960
  v_mfma_f32_16x16x32_bf16 v[164:167], v[64:67], v[44:47], v[164:167]
  ds_read_b64_tr_b16 v[108:109], v131 offset:38912
  v_mfma_f32_16x16x32_bf16 v[168:171], v[64:67], v[48:51], v[168:171]
  ds_read_b64_tr_b16 v[110:111], v131 offset:39424
  v_mfma_f32_16x16x32_bf16 v[172:175], v[64:67], v[52:55], v[172:175]
  ds_read_b64_tr_b16 v[112:113], v132 offset:38912
  s_waitcnt lgkmcnt(10)
  v_mfma_f32_16x16x32_bf16 v[196:199], v[68:71], v[56:59], v[196:199]
  ds_read_b64_tr_b16 v[114:115], v132 offset:39424
  v_mfma_f32_16x16x32_bf16 v[180:183], v[68:71], v[40:43], v[180:183]
  v_mfma_f32_16x16x32_bf16 v[184:187], v[68:71], v[44:47], v[184:187]
  v_mfma_f32_16x16x32_bf16 v[188:191], v[68:71], v[48:51], v[188:191]
  v_mfma_f32_16x16x32_bf16 v[192:195], v[68:71], v[52:55], v[192:195]
  s_waitcnt lgkmcnt(8)
  v_mfma_f32_16x16x32_bf16 v[156:159], v[104:107], v[100:103], v[156:159]
  s_waitcnt lgkmcnt(7)
  v_mfma_f32_16x16x32_bf16 v[140:143], v[104:107], v[84:87], v[140:143]
  s_waitcnt lgkmcnt(6)
  v_mfma_f32_16x16x32_bf16 v[144:147], v[104:107], v[88:91], v[144:147]
  s_waitcnt lgkmcnt(5)
  v_mfma_f32_16x16x32_bf16 v[148:151], v[104:107], v[92:95], v[148:151]
  s_waitcnt lgkmcnt(4)
  v_mfma_f32_16x16x32_bf16 v[152:155], v[104:107], v[96:99], v[152:155]
  s_waitcnt lgkmcnt(2)
  v_mfma_f32_16x16x32_bf16 v[176:179], v[108:111], v[100:103], v[176:179]
  v_mfma_f32_16x16x32_bf16 v[160:163], v[108:111], v[84:87], v[160:163]
  v_mfma_f32_16x16x32_bf16 v[164:167], v[108:111], v[88:91], v[164:167]
  v_mfma_f32_16x16x32_bf16 v[168:171], v[108:111], v[92:95], v[168:171]
  v_mfma_f32_16x16x32_bf16 v[172:175], v[108:111], v[96:99], v[172:175]
  s_waitcnt lgkmcnt(0)
  v_mfma_f32_16x16x32_bf16 v[196:199], v[112:115], v[100:103], v[196:199]
  v_mfma_f32_16x16x32_bf16 v[180:183], v[112:115], v[84:87], v[180:183]
  v_mfma_f32_16x16x32_bf16 v[184:187], v[112:115], v[88:91], v[184:187]
  v_mfma_f32_16x16x32_bf16 v[188:191], v[112:115], v[92:95], v[188:191]
  v_mfma_f32_16x16x32_bf16 v[192:195], v[112:115], v[96:99], v[192:195]
  s_waitcnt lgkmcnt(0)
  s_barrier
  ds_read_b64_tr_b16 v[60:61], v135 offset:0
  ds_read_b64_tr_b16 v[62:63], v135 offset:512
  ds_read_b128 v[56:59], v133 offset:8192
  ds_read_b128 v[40:43], v133 offset:0
  ds_read_b128 v[44:47], v133 offset:2048
  ds_read_b128 v[48:51], v133 offset:4096
  ds_read_b128 v[52:55], v133 offset:6144
  ds_read_b64_tr_b16 v[64:65], v136 offset:0
  ds_read_b64_tr_b16 v[66:67], v136 offset:512
  ds_read_b64_tr_b16 v[68:69], v137 offset:0
  ds_read_b64_tr_b16 v[70:71], v137 offset:512
  s_waitcnt lgkmcnt(8)
  v_mfma_f32_16x16x32_bf16 v[156:159], v[60:63], v[56:59], v[156:159]
  ds_read_b64_tr_b16 v[104:105], v135 offset:4096
  s_waitcnt lgkmcnt(8)
  v_mfma_f32_16x16x32_bf16 v[140:143], v[60:63], v[40:43], v[140:143]
  ds_read_b64_tr_b16 v[106:107], v135 offset:4608
  s_waitcnt lgkmcnt(8)
  v_mfma_f32_16x16x32_bf16 v[144:147], v[60:63], v[44:47], v[144:147]
  ds_read_b128 v[100:103], v134 offset:8192
  s_waitcnt lgkmcnt(8)
  v_mfma_f32_16x16x32_bf16 v[148:151], v[60:63], v[48:51], v[148:151]
  ds_read_b128 v[84:87], v134 offset:0
  s_waitcnt lgkmcnt(8)
  v_mfma_f32_16x16x32_bf16 v[152:155], v[60:63], v[52:55], v[152:155]
  ds_read_b128 v[88:91], v134 offset:2048
  s_waitcnt lgkmcnt(7)
  v_mfma_f32_16x16x32_bf16 v[176:179], v[64:67], v[56:59], v[176:179]
  ds_read_b128 v[92:95], v134 offset:4096
  v_mfma_f32_16x16x32_bf16 v[160:163], v[64:67], v[40:43], v[160:163]
  ds_read_b128 v[96:99], v134 offset:6144
  v_mfma_f32_16x16x32_bf16 v[164:167], v[64:67], v[44:47], v[164:167]
  ds_read_b64_tr_b16 v[108:109], v136 offset:4096
  v_mfma_f32_16x16x32_bf16 v[168:171], v[64:67], v[48:51], v[168:171]
  ds_read_b64_tr_b16 v[110:111], v136 offset:4608
  v_mfma_f32_16x16x32_bf16 v[172:175], v[64:67], v[52:55], v[172:175]
  ds_read_b64_tr_b16 v[112:113], v137 offset:4096
  s_waitcnt lgkmcnt(10)
  v_mfma_f32_16x16x32_bf16 v[196:199], v[68:71], v[56:59], v[196:199]
  ds_read_b64_tr_b16 v[114:115], v137 offset:4608
  v_mfma_f32_16x16x32_bf16 v[180:183], v[68:71], v[40:43], v[180:183]
  v_mfma_f32_16x16x32_bf16 v[184:187], v[68:71], v[44:47], v[184:187]
  v_mfma_f32_16x16x32_bf16 v[188:191], v[68:71], v[48:51], v[188:191]
  v_mfma_f32_16x16x32_bf16 v[192:195], v[68:71], v[52:55], v[192:195]
  s_waitcnt lgkmcnt(8)
  v_mfma_f32_16x16x32_bf16 v[156:159], v[104:107], v[100:103], v[156:159]
  s_waitcnt lgkmcnt(7)
  v_mfma_f32_16x16x32_bf16 v[140:143], v[104:107], v[84:87], v[140:143]
  s_waitcnt lgkmcnt(6)
  v_mfma_f32_16x16x32_bf16 v[144:147], v[104:107], v[88:91], v[144:147]
  s_waitcnt lgkmcnt(5)
  v_mfma_f32_16x16x32_bf16 v[148:151], v[104:107], v[92:95], v[148:151]
  s_waitcnt lgkmcnt(4)
  v_mfma_f32_16x16x32_bf16 v[152:155], v[104:107], v[96:99], v[152:155]
  s_waitcnt lgkmcnt(2)
  v_mfma_f32_16x16x32_bf16 v[176:179], v[108:111], v[100:103], v[176:179]
  v_mfma_f32_16x16x32_bf16 v[160:163], v[108:111], v[84:87], v[160:163]
  v_mfma_f32_16x16x32_bf16 v[164:167], v[108:111], v[88:91], v[164:167]
  v_mfma_f32_16x16x32_bf16 v[168:171], v[108:111], v[92:95], v[168:171]
  v_mfma_f32_16x16x32_bf16 v[172:175], v[108:111], v[96:99], v[172:175]
  s_waitcnt lgkmcnt(0)
  v_mfma_f32_16x16x32_bf16 v[196:199], v[112:115], v[100:103], v[196:199]
  v_mfma_f32_16x16x32_bf16 v[180:183], v[112:115], v[84:87], v[180:183]
  v_mfma_f32_16x16x32_bf16 v[184:187], v[112:115], v[88:91], v[184:187]
  v_mfma_f32_16x16x32_bf16 v[188:191], v[112:115], v[92:95], v[188:191]
  v_mfma_f32_16x16x32_bf16 v[192:195], v[112:115], v[96:99], v[192:195]
  s_waitcnt lgkmcnt(0)
  s_barrier
  ds_read_b64_tr_b16 v[60:61], v135 offset:34816
  ds_read_b64_tr_b16 v[62:63], v135 offset:35328
  ds_read_b128 v[56:59], v133 offset:43008
  ds_read_b128 v[40:43], v133 offset:34816
  ds_read_b128 v[44:47], v133 offset:36864
  ds_read_b128 v[48:51], v133 offset:38912
  ds_read_b128 v[52:55], v133 offset:40960
  ds_read_b64_tr_b16 v[64:65], v136 offset:34816
  ds_read_b64_tr_b16 v[66:67], v136 offset:35328
  ds_read_b64_tr_b16 v[68:69], v137 offset:34816
  ds_read_b64_tr_b16 v[70:71], v137 offset:35328
  s_waitcnt lgkmcnt(8)
  v_mfma_f32_16x16x32_bf16 v[156:159], v[60:63], v[56:59], v[156:159]
  ds_read_b64_tr_b16 v[104:105], v135 offset:38912
  ds_read_b64_tr_b16 v[106:107], v135 offset:39424
  s_waitcnt lgkmcnt(9)
  v_mfma_f32_16x16x32_bf16 v[140:143], v[60:63], v[40:43], v[140:143]
  ds_read_b128 v[100:103], v134 offset:43008
  ds_read_b128 v[84:87], v134 offset:34816
  s_waitcnt lgkmcnt(10)
  v_mfma_f32_16x16x32_bf16 v[144:147], v[60:63], v[44:47], v[144:147]
  ds_read_b128 v[88:91], v134 offset:36864
  ds_read_b128 v[92:95], v134 offset:38912
  s_waitcnt lgkmcnt(11)
  v_mfma_f32_16x16x32_bf16 v[148:151], v[60:63], v[48:51], v[148:151]
  ds_read_b128 v[96:99], v134 offset:40960
  ds_read_b64_tr_b16 v[108:109], v136 offset:38912
  s_waitcnt lgkmcnt(12)
  v_mfma_f32_16x16x32_bf16 v[152:155], v[60:63], v[52:55], v[152:155]
  ds_read_b64_tr_b16 v[110:111], v136 offset:39424
  ds_read_b64_tr_b16 v[112:113], v137 offset:38912
  s_waitcnt lgkmcnt(12)
  v_mfma_f32_16x16x32_bf16 v[176:179], v[64:67], v[56:59], v[176:179]
  ds_read_b64_tr_b16 v[114:115], v137 offset:39424
  ds_read_b32 v200, v139 offset:0
  v_mfma_f32_16x16x32_bf16 v[160:163], v[64:67], v[40:43], v[160:163]
  ds_read_b32 v201, v139 offset:64
  ds_read_b32 v202, v139 offset:128
  v_mfma_f32_16x16x32_bf16 v[164:167], v[64:67], v[44:47], v[164:167]
  ds_read_b32 v203, v139 offset:192
  ds_read_b32 v204, v139 offset:256
  v_mfma_f32_16x16x32_bf16 v[168:171], v[64:67], v[48:51], v[168:171]
  v_mfma_f32_16x16x32_bf16 v[172:175], v[64:67], v[52:55], v[172:175]
  s_waitcnt lgkmcnt(15)
  v_mfma_f32_16x16x32_bf16 v[196:199], v[68:71], v[56:59], v[196:199]
  v_mfma_f32_16x16x32_bf16 v[180:183], v[68:71], v[40:43], v[180:183]
  v_mfma_f32_16x16x32_bf16 v[184:187], v[68:71], v[44:47], v[184:187]
  v_mfma_f32_16x16x32_bf16 v[188:191], v[68:71], v[48:51], v[188:191]
  v_mfma_f32_16x16x32_bf16 v[192:195], v[68:71], v[52:55], v[192:195]
  s_waitcnt lgkmcnt(13)
  v_mfma_f32_16x16x32_bf16 v[156:159], v[104:107], v[100:103], v[156:159]
  s_waitcnt lgkmcnt(12)
  v_mfma_f32_16x16x32_bf16 v[140:143], v[104:107], v[84:87], v[140:143]
  s_waitcnt lgkmcnt(11)
  v_mfma_f32_16x16x32_bf16 v[144:147], v[104:107], v[88:91], v[144:147]
  s_waitcnt lgkmcnt(10)
  v_mfma_f32_16x16x32_bf16 v[148:151], v[104:107], v[92:95], v[148:151]
  s_waitcnt lgkmcnt(9)
  v_mfma_f32_16x16x32_bf16 v[152:155], v[104:107], v[96:99], v[152:155]
  s_waitcnt lgkmcnt(7)
  v_mfma_f32_16x16x32_bf16 v[176:179], v[108:111], v[100:103], v[176:179]
  v_mfma_f32_16x16x32_bf16 v[160:163], v[108:111], v[84:87], v[160:163]
  s_waitcnt lgkmcnt(4)
  v_fmac_f32_dpp v140, v156, v200 row_newbcast:0 row_mask:0xf bank_mask:0xf
  v_fmac_f32_dpp v141, v157, v200 row_newbcast:0 row_mask:0xf bank_mask:0xf
  v_fmac_f32_dpp v142, v158, v200 row_newbcast:0 row_mask:0xf bank_mask:0xf
  v_mfma_f32_16x16x32_bf16 v[164:167], v[108:111], v[88:91], v[164:167]
  v_fmac_f32_dpp v143, v159, v200 row_newbcast:0 row_mask:0xf bank_mask:0xf
  v_cvt_pk_bf16_f32 v208, v140, v141
  v_cvt_pk_bf16_f32 v209, v142, v143
  v_mfma_f32_16x16x32_bf16 v[168:171], v[108:111], v[92:95], v[168:171]
  ds_write_b64 v138, v[208:209] offset:0
  s_waitcnt lgkmcnt(4)
  v_fmac_f32_dpp v144, v156, v201 row_newbcast:0 row_mask:0xf bank_mask:0xf
  v_fmac_f32_dpp v145, v157, v201 row_newbcast:0 row_mask:0xf bank_mask:0xf
  v_mfma_f32_16x16x32_bf16 v[172:175], v[108:111], v[96:99], v[172:175]
  v_fmac_f32_dpp v146, v158, v201 row_newbcast:0 row_mask:0xf bank_mask:0xf
  v_fmac_f32_dpp v147, v159, v201 row_newbcast:0 row_mask:0xf bank_mask:0xf
  v_cvt_pk_bf16_f32 v210, v144, v145
  v_mfma_f32_16x16x32_bf16 v[196:199], v[112:115], v[100:103], v[196:199]
  v_cvt_pk_bf16_f32 v211, v146, v147
  ds_write_b64 v138, v[210:211] offset:6144
  s_waitcnt lgkmcnt(4)
  v_fmac_f32_dpp v148, v156, v202 row_newbcast:0 row_mask:0xf bank_mask:0xf
  v_mfma_f32_16x16x32_bf16 v[180:183], v[112:115], v[84:87], v[180:183]
  v_fmac_f32_dpp v149, v157, v202 row_newbcast:0 row_mask:0xf bank_mask:0xf
  v_fmac_f32_dpp v150, v158, v202 row_newbcast:0 row_mask:0xf bank_mask:0xf
  v_fmac_f32_dpp v151, v159, v202 row_newbcast:0 row_mask:0xf bank_mask:0xf
  v_mfma_f32_16x16x32_bf16 v[184:187], v[112:115], v[88:91], v[184:187]
  v_cvt_pk_bf16_f32 v212, v148, v149
  v_cvt_pk_bf16_f32 v213, v150, v151
  ds_write_b64 v138, v[212:213] offset:12288
  v_mfma_f32_16x16x32_bf16 v[188:191], v[112:115], v[92:95], v[188:191]
  s_waitcnt lgkmcnt(4)
  v_fmac_f32_dpp v152, v156, v203 row_newbcast:0 row_mask:0xf bank_mask:0xf
  v_fmac_f32_dpp v153, v157, v203 row_newbcast:0 row_mask:0xf bank_mask:0xf
  v_fmac_f32_dpp v154, v158, v203 row_newbcast:0 row_mask:0xf bank_mask:0xf
  v_mfma_f32_16x16x32_bf16 v[192:195], v[112:115], v[96:99], v[192:195]
  v_fmac_f32_dpp v155, v159, v203 row_newbcast:0 row_mask:0xf bank_mask:0xf
  v_cvt_pk_bf16_f32 v214, v152, v153
  v_cvt_pk_bf16_f32 v215, v154, v155
  ds_write_b64 v138, v[214:215] offset:18432
  s_waitcnt lgkmcnt(4)
  v_fmac_f32_dpp v156, v156, v204 row_newbcast:0 row_mask:0xf bank_mask:0xf
  v_fmac_f32_dpp v157, v157, v204 row_newbcast:0 row_mask:0xf bank_mask:0xf
  v_fmac_f32_dpp v158, v158, v204 row_newbcast:0 row_mask:0xf bank_mask:0xf
  v_fmac_f32_dpp v159, v159, v204 row_newbcast:0 row_mask:0xf bank_mask:0xf
  v_cvt_pk_bf16_f32 v208, v156, v157
  v_cvt_pk_bf16_f32 v209, v158, v159
  ds_write_b64 v138, v[208:209] offset:24576
  v_fmac_f32_dpp v160, v176, v200 row_newbcast:0 row_mask:0xf bank_mask:0xf
  v_fmac_f32_dpp v161, v177, v200 row_newbcast:0 row_mask:0xf bank_mask:0xf
  v_fmac_f32_dpp v162, v178, v200 row_newbcast:0 row_mask:0xf bank_mask:0xf
  v_fmac_f32_dpp v163, v179, v200 row_newbcast:0 row_mask:0xf bank_mask:0xf
  v_cvt_pk_bf16_f32 v210, v160, v161
  v_cvt_pk_bf16_f32 v211, v162, v163
  ds_write_b64 v138, v[210:211] offset:512
  v_fmac_f32_dpp v164, v176, v201 row_newbcast:0 row_mask:0xf bank_mask:0xf
  v_fmac_f32_dpp v165, v177, v201 row_newbcast:0 row_mask:0xf bank_mask:0xf
  v_fmac_f32_dpp v166, v178, v201 row_newbcast:0 row_mask:0xf bank_mask:0xf
  v_fmac_f32_dpp v167, v179, v201 row_newbcast:0 row_mask:0xf bank_mask:0xf
  v_cvt_pk_bf16_f32 v212, v164, v165
  v_cvt_pk_bf16_f32 v213, v166, v167
  ds_write_b64 v138, v[212:213] offset:6656
  v_fmac_f32_dpp v168, v176, v202 row_newbcast:0 row_mask:0xf bank_mask:0xf
  v_fmac_f32_dpp v169, v177, v202 row_newbcast:0 row_mask:0xf bank_mask:0xf
  v_fmac_f32_dpp v170, v178, v202 row_newbcast:0 row_mask:0xf bank_mask:0xf
  v_fmac_f32_dpp v171, v179, v202 row_newbcast:0 row_mask:0xf bank_mask:0xf
  v_cvt_pk_bf16_f32 v214, v168, v169
  v_cvt_pk_bf16_f32 v215, v170, v171
  ds_write_b64 v138, v[214:215] offset:12800
  v_fmac_f32_dpp v172, v176, v203 row_newbcast:0 row_mask:0xf bank_mask:0xf
  v_fmac_f32_dpp v173, v177, v203 row_newbcast:0 row_mask:0xf bank_mask:0xf
  v_fmac_f32_dpp v174, v178, v203 row_newbcast:0 row_mask:0xf bank_mask:0xf
  v_fmac_f32_dpp v175, v179, v203 row_newbcast:0 row_mask:0xf bank_mask:0xf
  v_cvt_pk_bf16_f32 v208, v172, v173
  v_cvt_pk_bf16_f32 v209, v174, v175
  ds_write_b64 v138, v[208:209] offset:18944
  v_fmac_f32_dpp v176, v176, v204 row_newbcast:0 row_mask:0xf bank_mask:0xf
  v_fmac_f32_dpp v177, v177, v204 row_newbcast:0 row_mask:0xf bank_mask:0xf
  v_fmac_f32_dpp v178, v178, v204 row_newbcast:0 row_mask:0xf bank_mask:0xf
  v_fmac_f32_dpp v179, v179, v204 row_newbcast:0 row_mask:0xf bank_mask:0xf
  v_cvt_pk_bf16_f32 v210, v176, v177
  v_cvt_pk_bf16_f32 v211, v178, v179
  ds_write_b64 v138, v[210:211] offset:25088
  v_fmac_f32_dpp v180, v196, v200 row_newbcast:0 row_mask:0xf bank_mask:0xf
  v_fmac_f32_dpp v181, v197, v200 row_newbcast:0 row_mask:0xf bank_mask:0xf
  v_fmac_f32_dpp v182, v198, v200 row_newbcast:0 row_mask:0xf bank_mask:0xf
  v_fmac_f32_dpp v183, v199, v200 row_newbcast:0 row_mask:0xf bank_mask:0xf
  v_cvt_pk_bf16_f32 v212, v180, v181
  v_cvt_pk_bf16_f32 v213, v182, v183
  ds_write_b64 v138, v[212:213] offset:1024
  v_fmac_f32_dpp v184, v196, v201 row_newbcast:0 row_mask:0xf bank_mask:0xf
  v_fmac_f32_dpp v185, v197, v201 row_newbcast:0 row_mask:0xf bank_mask:0xf
  v_fmac_f32_dpp v186, v198, v201 row_newbcast:0 row_mask:0xf bank_mask:0xf
  v_fmac_f32_dpp v187, v199, v201 row_newbcast:0 row_mask:0xf bank_mask:0xf
  v_cvt_pk_bf16_f32 v214, v184, v185
  v_cvt_pk_bf16_f32 v215, v186, v187
  ds_write_b64 v138, v[214:215] offset:7168
  v_fmac_f32_dpp v188, v196, v202 row_newbcast:0 row_mask:0xf bank_mask:0xf
  v_fmac_f32_dpp v189, v197, v202 row_newbcast:0 row_mask:0xf bank_mask:0xf
  v_fmac_f32_dpp v190, v198, v202 row_newbcast:0 row_mask:0xf bank_mask:0xf
  v_fmac_f32_dpp v191, v199, v202 row_newbcast:0 row_mask:0xf bank_mask:0xf
  v_cvt_pk_bf16_f32 v208, v188, v189
  v_cvt_pk_bf16_f32 v209, v190, v191
  ds_write_b64 v138, v[208:209] offset:13312
  v_fmac_f32_dpp v192, v196, v203 row_newbcast:0 row_mask:0xf bank_mask:0xf
  v_fmac_f32_dpp v193, v197, v203 row_newbcast:0 row_mask:0xf bank_mask:0xf
  v_fmac_f32_dpp v194, v198, v203 row_newbcast:0 row_mask:0xf bank_mask:0xf
  v_fmac_f32_dpp v195, v199, v203 row_newbcast:0 row_mask:0xf bank_mask:0xf
  v_cvt_pk_bf16_f32 v210, v192, v193
  v_cvt_pk_bf16_f32 v211, v194, v195
  ds_write_b64 v138, v[210:211] offset:19456
  v_fmac_f32_dpp v196, v196, v204 row_newbcast:0 row_mask:0xf bank_mask:0xf
  v_fmac_f32_dpp v197, v197, v204 row_newbcast:0 row_mask:0xf bank_mask:0xf
  v_fmac_f32_dpp v198, v198, v204 row_newbcast:0 row_mask:0xf bank_mask:0xf
  v_fmac_f32_dpp v199, v199, v204 row_newbcast:0 row_mask:0xf bank_mask:0xf
  v_cvt_pk_bf16_f32 v212, v196, v197
  v_cvt_pk_bf16_f32 v213, v198, v199
  ds_write_b64 v138, v[212:213] offset:25600
  ds_read_b32 v39, v36
  ds_read_b128 v[120:123], v37
  ds_read_b128 v[124:127], v38
  s_waitcnt vmcnt(0) lgkmcnt(0)
LAjoin:
  s_barrier
  ds_read_b64 v[100:101], v32
  ds_read_b64 v[102:103], v32 offset:512
  ds_read_b64 v[104:105], v32 offset:1024
  ds_read_b64 v[106:107], v32 offset:1536
  ds_read_b64 v[108:109], v35 offset:1024
  ds_read_b64 v[110:111], v35 offset:1536
  ds_read_b64_tr_b16 v[112:113], v34 offset:2048
  ds_read_b64_tr_b16 v[114:115], v33 offset:2048
  ds_read_b64_tr_b16 v[116:117], v34 offset:2560
  ds_read_b64_tr_b16 v[118:119], v33 offset:2560
  v_mul_f32 v13, 0x3e8b97f6, v39
  v_readfirstlane_b32 s47, v17
  s_nop 1
  s_cmp_lg_u32 s47, 0
  s_cbranch_scc1 Lnskip_7
  s_mov_b32 s3, 400000
  v_mov_b32 v7, 0
Lnpoll_8:
  buffer_load_dword v6, v7, s[40:43], 0 offen sc1
  s_waitcnt vmcnt(0)
  v_readfirstlane_b32 s47, v6
  s_sub_u32 s3, s3, 1
  s_cbranch_scc1 Lnskip_7
  s_nop 1
  s_cmp_eq_u32 s47, 0
  s_cbranch_scc1 Lnpoll_8
Lnskip_7:
  s_nop 3
  s_waitcnt lgkmcnt(8)
  v_cndmask_b32 v102, 0, v102, s[94:95]
  v_cndmask_b32 v103, 0, v103, s[94:95]
  s_waitcnt lgkmcnt(6)
  s_nop 0
  v_mfma_f32_16x16x32_bf16 v[80:83], v[104:107], v[100:103], v[80:83]
  s_waitcnt lgkmcnt(4)
  v_mfma_f32_16x16x32_bf16 v[76:79], v[108:111], v[100:103], v[76:79]
  s_nop 5
  v_mul_f32 v80, v120, v80
  v_mul_f32 v81, v121, v81
  v_mul_f32 v82, v122, v82
  v_mul_f32 v83, v123, v83
  v_mul_f32 v76, v124, v76
  v_mul_f32 v77, v125, v77
  v_mul_f32 v78, v126, v78
  v_mul_f32 v79, v127, v79
  v_max3_f32 v8, v80, v81, v82
  v_max3_f32 v9, v83, v76, v77
  v_max3_f32 v8, v8, v78, v79
  v_max_f32 v8, v8, v9
  v_mov_b32 v9, v8
  s_nop 1
  v_permlane32_swap_b32 v9, v8
  v_max_f32 v8, v8, v9
  v_mov_b32 v9, v8
  s_nop 1
  v_permlane16_swap_b32 v9, v8
  v_max_f32 v8, v8, v9
  v_mul_f32 v8, v13, v8
  v_fma_f32 v76, v76, v13, -v8
  v_fma_f32 v77, v77, v13, -v8
  v_fma_f32 v78, v78, v13, -v8
  v_fma_f32 v79, v79, v13, -v8
  v_fma_f32 v80, v80, v13, -v8
  v_fma_f32 v81, v81, v13, -v8
  v_fma_f32 v82, v82, v13, -v8
  v_fma_f32 v83, v83, v13, -v8
  v_exp_f32 v76, v76
  v_exp_f32 v77, v77
  v_exp_f32 v78, v78
  v_exp_f32 v79, v79
  v_exp_f32 v80, v80
  v_exp_f32 v81, v81
  v_exp_f32 v82, v82
  v_exp_f32 v83, v83
  v_add_f32 v9, v76, v77
  v_add_f32 v10, v78, v79
  v_add_f32 v11, v80, v81
  v_add_f32 v12, v82, v83
  v_add_f32 v9, v9, v10
  v_add_f32 v11, v11, v12
  v_add_f32 v9, v9, v11
  v_mul_f32 v76, v124, v76
  v_mul_f32 v77, v125, v77
  v_mul_f32 v78, v126, v78
  v_mul_f32 v79, v127, v79
  v_mul_f32 v80, v120, v80
  v_mul_f32 v81, v121, v81
  v_mul_f32 v82, v122, v82
  v_mul_f32 v83, v123, v83
  v_cvt_pk_bf16_f32 v96, v76, v77
  v_cvt_pk_bf16_f32 v97, v78, v79
  v_cvt_pk_bf16_f32 v98, v80, v81
  v_cvt_pk_bf16_f32 v99, v82, v83
  v_mov_b32 v10, v9
  s_nop 0
  s_waitcnt lgkmcnt(2)
  v_mfma_f32_16x16x32_bf16 v[40:43], v[112:115], v[96:99], 0
  s_waitcnt lgkmcnt(0)
  v_mfma_f32_16x16x32_bf16 v[44:47], v[116:119], v[96:99], 0
  v_permlane32_swap_b32 v10, v9
  v_add_f32 v9, v9, v10
  v_mov_b32 v10, v9
  s_nop 1
  v_permlane16_swap_b32 v10, v9
  v_add_f32 v9, v9, v10
  v_rcp_f32 v9, v9
  s_nop 0
  v_mul_f32 v40, v9, v40
  v_mul_f32 v41, v9, v41
  v_mul_f32 v42, v9, v42
  v_mul_f32 v43, v9, v43
  v_mul_f32 v44, v9, v44
  v_mul_f32 v45, v9, v45
  v_mul_f32 v46, v9, v46
  v_mul_f32 v47, v9, v47
  v_cvt_pk_bf16_f32 v124, v40, v41
  v_cvt_pk_bf16_f32 v125, v42, v43
  v_cvt_pk_bf16_f32 v126, v44, v45
  v_cvt_pk_bf16_f32 v127, v46, v47
  v_cndmask_b32 v126, 0, v126, s[94:95]
  v_cndmask_b32 v127, 0, v127, s[94:95]
  buffer_store_dwordx4 v[124:127], v14, s[36:39], s98 offen sc1
  s_cmp_lt_u32 s46, 28
  s_cbranch_scc1 LgoB
  s_waitcnt vmcnt(0)
  s_barrier
  s_cmp_lg_u32 s44, 0
  s_cbranch_scc1 Lpub_9
  s_mov_b64 exec, 1
  v_mov_b32 v6, s47
  v_mov_b32 v7, 0
  buffer_store_dword v6, v7, s[36:39], s99 offen sc1
  s_mov_b64 exec, -1
Lpub_9:
  s_lshl_b32 s55, s85, 3
  s_add_u32 s55, s55, s45
  s_mul_i32 s55, s55, 50176
  v_min_u32 v8, 391, v0
  v_lshlrev_b32 v8, 7, v8
  buffer_load_dword v40, v8, s[24:27], s55 offen
  buffer_load_dword v41, v8, s[28:31], s55 offen
  s_branch Lfin
LgoB:
  v_xor_b32 v32, 32, v28
  v_xor_b32 v33, 32, v29
  v_xor_b32 v34, 32, v30
  v_xor_b32 v35, 32, v31
  s_and_b32 s50, s44, 3
  s_lshr_b32 s51, s44, 2
  s_lshl_b32 s52, s84, 2
  s_add_u32 s52, s52, s50
  s_lshr_b32 s55, s52, 1
  s_lshl_b32 s55, s55, 5
  s_and_b32 s56, s52, 1
  s_add_u32 s55, s55, s56
  v_lshl_add_u32 v8, v3, 1, s55
  v_mul_u32_u24 v8, 896, v8
  v_lshrrev_b32 v9, 1, v2
  v_and_b32 v10, 1, v2
  v_lshl_add_u32 v9, v10, 1, v9
  v_lshl_add_u32 v8, v9, 4, v8
  v_lshlrev_b32 v9, 8, v9
  v_lshl_add_u32 v36, v3, 4, v9
  s_lshl_b32 s54, s85, 1
  s_add_u32 s54, s54, s51
  s_lshl_b32 s57, s54, 6
  s_add_u32 m0, s53, 106496
  s_mov_b32 s55, 688128
  buffer_load_dwordx4 v16, s[20:23], s55 offen lds
  s_add_u32 m0, s53, 114688
  s_mov_b32 s55, 802816
  buffer_load_dwordx4 v16, s[20:23], s55 offen lds
  s_add_u32 m0, s53, 122880
  s_mov_b32 s55, 917504
  buffer_load_dwordx4 v16, s[20:23], s55 offen lds
  s_add_u32 m0, s53, 131072
  s_mov_b32 s55, 1032192
  buffer_load_dwordx4 v16, s[20:23], s55 offen lds
  ds_read_b64_tr_b16 v[128:129], v28 offset:0
  ds_read_b64_tr_b16 v[130:131], v30 offset:0
  ds_read_b64_tr_b16 v[132:133], v32 offset:0
  ds_read_b64_tr_b16 v[134:135], v34 offset:0
  ds_read_b64_tr_b16 v[136:137], v29 offset:0
  ds_read_b64_tr_b16 v[138:139], v31 offset:0
  ds_read_b64_tr_b16 v[140:141], v33 offset:0
  ds_read_b64_tr_b16 v[142:143], v35 offset:0
  ds_read_b64_tr_b16 v[144:145], v29 offset:3584
  ds_read_b64_tr_b16 v[146:147], v31 offset:3584
  ds_read_b64_tr_b16 v[148:149], v33 offset:3584
  ds_read_b64_tr_b16 v[150:151], v35 offset:3584
  ds_read_b64_tr_b16 v[152:153], v28 offset:3584
  ds_read_b64_tr_b16 v[154:155], v30 offset:3584
  ds_read_b64_tr_b16 v[156:157], v32 offset:3584
  ds_read_b64_tr_b16 v[158:159], v34 offset:3584
  ds_read_b64_tr_b16 v[160:161], v28 offset:7168
  ds_read_b64_tr_b16 v[162:163], v30 offset:7168
  ds_read_b64_tr_b16 v[164:165], v32 offset:7168
  ds_read_b64_tr_b16 v[166:167], v34 offset:7168
  ds_read_b64_tr_b16 v[168:169], v29 offset:7168
  ds_read_b64_tr_b16 v[170:171], v31 offset:7168
  ds_read_b64_tr_b16 v[172:173], v33 offset:7168
  ds_read_b64_tr_b16 v[174:175], v35 offset:7168
  ds_read_b64_tr_b16 v[176:177], v29 offset:10752
  ds_read_b64_tr_b16 v[178:179], v31 offset:10752
  ds_read_b64_tr_b16 v[180:181], v33 offset:10752
  ds_read_b64_tr_b16 v[182:183], v35 offset:10752
  ds_read_b64_tr_b16 v[184:185], v28 offset:10752
  ds_read_b64_tr_b16 v[186:187], v30 offset:10752
  ds_read_b64_tr_b16 v[188:189], v32 offset:10752
  ds_read_b64_tr_b16 v[190:191], v34 offset:10752
  ds_read_b64_tr_b16 v[192:193], v28 offset:14336
  ds_read_b64_tr_b16 v[194:195], v30 offset:14336
  ds_read_b64_tr_b16 v[196:197], v32 offset:14336
  ds_read_b64_tr_b16 v[198:199], v34 offset:14336
  ds_read_b64_tr_b16 v[200:201], v29 offset:14336
  ds_read_b64_tr_b16 v[202:203], v31 offset:14336
  ds_read_b64_tr_b16 v[204:205], v33 offset:14336
  ds_read_b64_tr_b16 v[206:207], v35 offset:14336
  s_waitcnt vmcnt(4)
  s_barrier
  s_cmp_lg_u32 s44, 0
  s_cbranch_scc1 Lpub_10
  s_mov_b64 exec, 1
  v_mov_b32 v6, s47
  v_mov_b32 v7, 0
  buffer_store_dword v6, v7, s[36:39], s99 offen sc1
  s_mov_b64 exec, -1
Lpub_10:
  buffer_load_dwordx4 v[20:23], v8, s[8:11], s57 offen
  s_add_u32 m0, s53, 57344
  s_mov_b32 s55, 0
  buffer_load_dwordx4 v16, s[20:23], s55 offen lds
  s_add_u32 m0, s53, 65536
  s_mov_b32 s55, 114688
  buffer_load_dwordx4 v16, s[20:23], s55 offen lds
  s_add_u32 m0, s53, 73728
  s_mov_b32 s55, 229376
  buffer_load_dwordx4 v16, s[20:23], s55 offen lds
  s_add_u32 m0, s53, 81920
  s_mov_b32 s55, 344064
  buffer_load_dwordx4 v16, s[20:23], s55 offen lds
  s_add_u32 m0, s53, 90112
  s_mov_b32 s55, 458752
  buffer_load_dwordx4 v16, s[20:23], s55 offen lds
  s_add_u32 m0, s53, 98304
  s_mov_b32 s55, 573440
  buffer_load_dwordx4 v16, s[20:23], s55 offen lds
  ds_read_b64_tr_b16 v[208:209], v29 offset:17920
  ds_read_b64_tr_b16 v[210:211], v31 offset:17920
  ds_read_b64_tr_b16 v[212:213], v33 offset:17920
  ds_read_b64_tr_b16 v[214:215], v35 offset:17920
  ds_read_b64_tr_b16 v[216:217], v28 offset:17920
  ds_read_b64_tr_b16 v[218:219], v30 offset:17920
  ds_read_b64_tr_b16 v[220:221], v32 offset:17920
  ds_read_b64_tr_b16 v[222:223], v34 offset:17920
  ds_read_b64_tr_b16 v[224:225], v28 offset:21504
  ds_read_b64_tr_b16 v[226:227], v30 offset:21504
  ds_read_b64_tr_b16 v[228:229], v32 offset:21504
  ds_read_b64_tr_b16 v[230:231], v34 offset:21504
  ds_read_b64_tr_b16 v[232:233], v29 offset:21504
  ds_read_b64_tr_b16 v[234:235], v31 offset:21504
  ds_read_b64_tr_b16 v[236:237], v33 offset:21504
  ds_read_b64_tr_b16 v[238:239], v35 offset:21504
  ds_read_b64_tr_b16 v[240:241], v29 offset:25088
  ds_read_b64_tr_b16 v[242:243], v31 offset:25088
  ds_read_b64_tr_b16 v[244:245], v33 offset:25088
  ds_read_b64_tr_b16 v[246:247], v35 offset:25088
  ds_read_b64_tr_b16 v[248:249], v28 offset:25088
  ds_read_b64_tr_b16 v[250:251], v30 offset:25088
  ds_read_b64_tr_b16 v[252:253], v32 offset:25088
  ds_read_b64_tr_b16 v[254:255], v34 offset:25088
  v_and_b32 v8, 1, v2
  v_lshl_or_b32 v8, v8, 2, v4
  v_lshlrev_b32 v8, 1, v8
  v_lshrrev_b32 v9, 1, v5
  s_lshl_b32 s55, s44, 1
  v_add_u32 v9, s55, v9
  v_xor_b32 v8, v8, v9
  v_lshl_add_u32 v9, v2, 3, v4
  v_lshlrev_b32 v9, 8, v9
  v_lshl_add_u32 v9, v8, 4, v9
  v_and_b32 v8, 1, v5
  v_lshl_add_u32 v17, v8, 3, v9
  v_add_u32 v18, 57344, v17
  v_add_u32 v19, 114688, v17
  v_mov_b32 v28, v36
  s_waitcnt vmcnt(6)
  v_permlane16_swap_b32 v20, v22
  v_permlane16_swap_b32 v21, v23
  v_lshlrev_b32 v64, 16, v20
  v_and_b32 v65, 0xffff0000, v20
  v_lshlrev_b32 v66, 16, v21
  v_and_b32 v67, 0xffff0000, v21
  v_lshlrev_b32 v68, 16, v22
  v_and_b32 v69, 0xffff0000, v22
  v_lshlrev_b32 v70, 16, v23
  v_and_b32 v71, 0xffff0000, v23
  s_lshl_b32 s56, s52, 4
  s_lshl_b32 s57, s51, 3
  s_add_u32 s56, s56, s57
  s_lshl_b32 s56, s56, 10
  s_add_u32 s57, s56, 4096
  s_lshl_b32 s55, s44, 11
  s_add_u32 s55, s55, 139264
  v_add_u32 v12, s55, v14
  s_xor_b32 s55, s44, 4
  s_lshl_b32 s55, s55, 11
  s_add_u32 s55, s55, 139264
  v_add_u32 v13, s55, v14
  s_mul_i32 s58, s52, 14
  s_add_u32 s58, s58, s54
  s_lshl_b32 s59, s58, 7
  s_add_u32 s59, s59, 4194304
  s_lshl_b32 s58, s58, 10
  s_add_u32 s58, s58, 2097152
  s_lshl_b32 s60, s84, 7
  s_add_u32 s60, s60, 16777216
  s_lshr_b32 s61, s84, 1
  s_lshl_b32 s61, s61, 7
  s_and_b32 s55, s84, 1
  s_mul_i32 s55, s55, 28
  s_add_u32 s61, s61, s55
  s_lshl_b32 s55, s85, 2
  s_add_u32 s61, s61, s55
  s_add_u32 s61, s61, 16785408
  v_lshlrev_b32 v11, 3, v3
  s_waitcnt lgkmcnt(0)
  s_cmp_lg_u32 s44, 0
  s_cbranch_scc1 Lskip_11
  v_lshlrev_b32 v7, 2, v1
  s_mov_b32 exec_lo, 0xff
  s_mov_b32 exec_hi, 0x0
  s_mov_b32 s3, 400000
Lpoll_12:
  buffer_load_dword v6, v7, s[36:39], s60 offen sc1
  s_waitcnt vmcnt(0)
  v_cmp_ne_u32 vcc, s47, v6
  s_sub_u32 s3, s3, 1
  s_cbranch_scc1 Ldone_13
  s_nop 1
  s_cmp_lg_u64 vcc, 0
  s_cbranch_scc1 Lpoll_12
Ldone_13:
  s_mov_b64 exec, -1
Lskip_11:
  s_barrier
  buffer_load_dwordx4 v[32:35], v14, s[36:39], s56 offen offset:0 sc1
  buffer_load_dwordx4 v[36:39], v14, s[36:39], s56 offen offset:1024 sc1
  buffer_load_dwordx4 v[40:43], v14, s[36:39], s56 offen offset:2048 sc1
  buffer_load_dwordx4 v[44:47], v14, s[36:39], s56 offen offset:3072 sc1
  buffer_load_dwordx4 v[48:51], v14, s[36:39], s57 offen offset:0 sc1
  buffer_load_dwordx4 v[52:55], v14, s[36:39], s57 offen offset:1024 sc1
  buffer_load_dwordx4 v[56:59], v14, s[36:39], s57 offen offset:2048 sc1
  buffer_load_dwordx4 v[60:63], v14, s[36:39], s57 offen offset:3072 sc1
  s_barrier
  s_add_u32 m0, s53, 0
  s_mov_b32 s55, 1146880
  buffer_load_dwordx4 v16, s[20:23], s55 offen lds
  s_waitcnt vmcnt(8)
  v_mfma_f32_16x16x32_bf16 v[72:75], v[136:139], v[32:35], 0
  v_mfma_f32_16x16x32_bf16 v[76:79], v[140:143], v[32:35], 0
  v_mfma_f32_16x16x32_bf16 v[64:67], v[128:131], v[32:35], v[64:67]
  v_mfma_f32_16x16x32_bf16 v[68:71], v[132:135], v[32:35], v[68:71]
  s_add_u32 m0, s53, 8192
  s_mov_b32 s55, 1261568
  buffer_load_dwordx4 v16, s[20:23], s55 offen lds
  s_waitcnt vmcnt(8)
  v_mfma_f32_16x16x32_bf16 v[72:75], v[152:155], v[36:39], v[72:75]
  v_mfma_f32_16x16x32_bf16 v[76:79], v[156:159], v[36:39], v[76:79]
  v_mfma_f32_16x16x32_bf16 v[64:67], v[144:147], v[36:39], v[64:67]
  v_mfma_f32_16x16x32_bf16 v[68:71], v[148:151], v[36:39], v[68:71]
  s_add_u32 m0, s53, 16384
  s_mov_b32 s55, 1376256
  buffer_load_dwordx4 v16, s[20:23], s55 offen lds
  s_waitcnt vmcnt(8)
  v_mfma_f32_16x16x32_bf16 v[72:75], v[168:171], v[40:43], v[72:75]
  v_mfma_f32_16x16x32_bf16 v[76:79], v[172:175], v[40:43], v[76:79]
  v_mfma_f32_16x16x32_bf16 v[64:67], v[160:163], v[40:43], v[64:67]
  v_mfma_f32_16x16x32_bf16 v[68:71], v[164:167], v[40:43], v[68:71]
  s_add_u32 m0, s53, 24576
  s_mov_b32 s55, 1490944
  buffer_load_dwordx4 v16, s[20:23], s55 offen lds
  s_waitcnt vmcnt(8)
  v_mfma_f32_16x16x32_bf16 v[72:75], v[184:187], v[44:47], v[72:75]
  v_mfma_f32_16x16x32_bf16 v[76:79], v[188:191], v[44:47], v[76:79]
  v_mfma_f32_16x16x32_bf16 v[64:67], v[176:179], v[44:47], v[64:67]
  v_mfma_f32_16x16x32_bf16 v[68:71], v[180:183], v[44:47], v[68:71]
  s_add_u32 m0, s53, 32768
  s_mov_b32 s55, 0
  buffer_load_dwordx4 v16, s[24:27], s55 offen lds
  s_waitcnt vmcnt(8)
  v_mfma_f32_16x16x32_bf16 v[72:75], v[200:203], v[48:51], v[72:75]
  v_mfma_f32_16x16x32_bf16 v[76:79], v[204:207], v[48:51], v[76:79]
  v_mfma_f32_16x16x32_bf16 v[64:67], v[192:195], v[48:51], v[64:67]
  v_mfma_f32_16x16x32_bf16 v[68:71], v[196:199], v[48:51], v[68:71]
  s_add_u32 m0, s53, 40960
  s_mov_b32 s55, 114688
  buffer_load_dwordx4 v16, s[24:27], s55 offen lds
  s_waitcnt vmcnt(8)
  v_mfma_f32_16x16x32_bf16 v[72:75], v[216:219], v[52:55], v[72:75]
  v_mfma_f32_16x16x32_bf16 v[76:79], v[220:223], v[52:55], v[76:79]
  v_mfma_f32_16x16x32_bf16 v[64:67], v[208:211], v[52:55], v[64:67]
  v_mfma_f32_16x16x32_bf16 v[68:71], v[212:215], v[52:55], v[68:71]
  s_add_u32 m0, s53, 49152
  s_mov_b32 s55, 229376
  buffer_load_dwordx4 v16, s[24:27], s55 offen lds
  s_waitcnt vmcnt(8)
  v_mfma_f32_16x16x32_bf16 v[72:75], v[232:235], v[56:59], v[72:75]
  v_mfma_f32_16x16x32_bf16 v[76:79], v[236:239], v[56:59], v[76:79]
  v_mfma_f32_16x16x32_bf16 v[64:67], v[224:227], v[56:59], v[64:67]
  v_mfma_f32_16x16x32_bf16 v[68:71], v[228:231], v[56:59], v[68:71]
  s_waitcnt vmcnt(7)
  v_mfma_f32_16x16x32_bf16 v[72:75], v[248:251], v[60:63], v[72:75]
  v_mfma_f32_16x16x32_bf16 v[76:79], v[252:255], v[60:63], v[76:79]
  v_mfma_f32_16x16x32_bf16 v[64:67], v[240:243], v[60:63], v[64:67]
  v_mfma_f32_16x16x32_bf16 v[68:71], v[244:247], v[60:63], v[68:71]
  s_nop 4
  ds_write_b128 v12, v[72:75]
  ds_write_b128 v12, v[76:79] offset:1024
  s_waitcnt lgkmcnt(0)
  s_barrier
  ds_read_b128 v[72:75], v13
  ds_read_b128 v[76:79], v13 offset:1024
  v_mov_b32 v8, 0
  v_mov_b32 v9, 0
  v_mov_b32 v6, 0
  v_mov_b32 v7, 0
  v_mov_b32 v10, 0x3f803f80
  s_waitcnt lgkmcnt(1)
  v_add_f32 v64, v64, v72
  v_add_f32 v65, v65, v73
  v_add_f32 v66, v66, v74
  v_add_f32 v67, v67, v75
  s_waitcnt lgkmcnt(0)
  v_add_f32 v68, v68, v76
  v_add_f32 v69, v69, v77
  v_add_f32 v70, v70, v78
  v_add_f32 v71, v71, v79
  v_cvt_pk_bf16_f32 v24, v64, v65
  v_cvt_pk_bf16_f32 v25, v66, v67
  v_cvt_pk_bf16_f32 v26, v68, v69
  v_cvt_pk_bf16_f32 v27, v70, v71
  s_nop 0
  v_permlane16_swap_b32 v24, v26
  v_permlane16_swap_b32 v25, v27
  buffer_store_dwordx4 v[24:27], v28, s[36:39], s58 offen sc1
  v_dot2c_f32_bf16 v6, v24, v10
  v_dot2c_f32_bf16 v7, v24, v24
  v_dot2c_f32_bf16 v8, v25, v10
  v_dot2c_f32_bf16 v9, v25, v25
  v_dot2c_f32_bf16 v6, v26, v10
  v_dot2c_f32_bf16 v7, v26, v26
  v_dot2c_f32_bf16 v8, v27, v10
  v_dot2c_f32_bf16 v9, v27, v27
  s_nop 1
  v_add_f32 v8, v8, v6
  v_add_f32 v9, v9, v7
  v_mov_b32 v6, v8
  v_mov_b32 v7, v9
  s_nop 0
  v_permlane32_swap_b32 v6, v8
  v_permlane32_swap_b32 v7, v9
  v_add_f32 v8, v8, v6
  v_add_f32 v9, v9, v7
  v_mov_b32 v6, v8
  v_mov_b32 v7, v9
  s_nop 0
  v_permlane16_swap_b32 v6, v8
  v_permlane16_swap_b32 v7, v9
  v_add_f32 v8, v8, v6
  v_add_f32 v9, v9, v7
  s_mov_b64 exec, 0xffff
  buffer_store_dwordx2 v[8:9], v11, s[36:39], s59 offen sc1
  s_mov_b64 exec, -1
  s_add_u32 m0, s53, 155648
  s_mov_b32 s55, 1490944
  buffer_load_dwordx4 v16, s[24:27], s55 offen lds
  ds_read_b64_tr_b16 v[80:81], v18 offset:0
  ds_read_b64_tr_b16 v[82:83], v18 offset:1024
  ds_read_b64_tr_b16 v[84:85], v18 offset:8192
  ds_read_b64_tr_b16 v[86:87], v18 offset:9216
  ds_read_b64_tr_b16 v[88:89], v18 offset:16384
  ds_read_b64_tr_b16 v[90:91], v18 offset:17408
  ds_read_b64_tr_b16 v[92:93], v18 offset:24576
  ds_read_b64_tr_b16 v[94:95], v18 offset:25600
  ds_read_b64_tr_b16 v[96:97], v18 offset:32768
  ds_read_b64_tr_b16 v[98:99], v18 offset:33792
  ds_read_b64_tr_b16 v[100:101], v18 offset:40960
  ds_read_b64_tr_b16 v[102:103], v18 offset:41984
  ds_read_b64_tr_b16 v[104:105], v18 offset:49152
  ds_read_b64_tr_b16 v[106:107], v18 offset:50176
  ds_read_b64_tr_b16 v[108:109], v19 offset:0
  ds_read_b64_tr_b16 v[110:111], v19 offset:1024
  ds_read_b64_tr_b16 v[112:113], v19 offset:8192
  ds_read_b64_tr_b16 v[114:115], v19 offset:9216
  ds_read_b64_tr_b16 v[116:117], v19 offset:16384
  ds_read_b64_tr_b16 v[118:119], v19 offset:17408
  s_waitcnt vmcnt(1) lgkmcnt(0)
  s_barrier
  s_cmp_lg_u32 s44, 0
  s_cbranch_scc1 Lpub_14
  s_mov_b64 exec, 1
  v_mov_b32 v6, s47
  v_mov_b32 v7, 0
  buffer_store_dword v6, v7, s[36:39], s61 offen sc1
  s_mov_b64 exec, -1
Lpub_14:
  s_add_u32 m0, s53, 57344
  s_mov_b32 s55, 344064
  buffer_load_dwordx4 v16, s[24:27], s55 offen lds
  s_add_u32 m0, s53, 65536
  s_mov_b32 s55, 458752
  buffer_load_dwordx4 v16, s[24:27], s55 offen lds
  s_add_u32 m0, s53, 73728
  s_mov_b32 s55, 573440
  buffer_load_dwordx4 v16, s[24:27], s55 offen lds
  s_add_u32 m0, s53, 81920
  s_mov_b32 s55, 688128
  buffer_load_dwordx4 v16, s[24:27], s55 offen lds
  s_add_u32 m0, s53, 90112
  s_mov_b32 s55, 802816
  buffer_load_dwordx4 v16, s[24:27], s55 offen lds
  s_add_u32 m0, s53, 98304
  s_mov_b32 s55, 917504
  buffer_load_dwordx4 v16, s[24:27], s55 offen lds
  s_add_u32 m0, s53, 106496
  s_mov_b32 s55, 1032192
  buffer_load_dwordx4 v16, s[24:27], s55 offen lds
  s_add_u32 m0, s53, 114688
  s_mov_b32 s55, 1146880
  buffer_load_dwordx4 v16, s[24:27], s55 offen lds
  s_add_u32 m0, s53, 122880
  s_mov_b32 s55, 1261568
  buffer_load_dwordx4 v16, s[24:27], s55 offen lds
  s_add_u32 m0, s53, 131072
  s_mov_b32 s55, 1376256
  buffer_load_dwordx4 v16, s[24:27], s55 offen lds
  ds_read_b64_tr_b16 v[120:121], v17 offset:0
  ds_read_b64_tr_b16 v[122:123], v17 offset:1024
  ds_read_b64_tr_b16 v[124:125], v17 offset:8192
  ds_read_b64_tr_b16 v[126:127], v17 offset:9216
  ds_read_b64_tr_b16 v[128:129], v17 offset:16384
  ds_read_b64_tr_b16 v[130:131], v17 offset:17408
  ds_read_b64_tr_b16 v[132:133], v17 offset:24576
  ds_read_b64_tr_b16 v[134:135], v17 offset:25600
  ds_read_b64_tr_b16 v[136:137], v17 offset:32768
  ds_read_b64_tr_b16 v[138:139], v17 offset:33792
  ds_read_b64_tr_b16 v[140:141], v17 offset:40960
  ds_read_b64_tr_b16 v[142:143], v17 offset:41984
  ds_read_b64_tr_b16 v[144:145], v17 offset:49152
  ds_read_b64_tr_b16 v[146:147], v17 offset:50176
  v_mov_b32 v20, 0x3f803f80
  v_mov_b32 v21, 0x3f803f80
  v_mov_b32 v22, 0x3f803f80
  v_mov_b32 v23, 0x3f803f80
  s_nop 1
  v_mfma_f32_16x16x32_bf16 v[24:27], v[80:83], v[20:23], 0
  v_mfma_f32_16x16x32_bf16 v[24:27], v[84:87], v[20:23], v[24:27]
  v_mfma_f32_16x16x32_bf16 v[24:27], v[88:91], v[20:23], v[24:27]
  v_mfma_f32_16x16x32_bf16 v[24:27], v[92:95], v[20:23], v[24:27]
  v_mfma_f32_16x16x32_bf16 v[24:27], v[96:99], v[20:23], v[24:27]
  v_mfma_f32_16x16x32_bf16 v[24:27], v[100:103], v[20:23], v[24:27]
  v_mfma_f32_16x16x32_bf16 v[24:27], v[104:107], v[20:23], v[24:27]
  v_mfma_f32_16x16x32_bf16 v[24:27], v[108:111], v[20:23], v[24:27]
  v_mfma_f32_16x16x32_bf16 v[24:27], v[112:115], v[20:23], v[24:27]
  v_mfma_f32_16x16x32_bf16 v[24:27], v[116:119], v[20:23], v[24:27]
  s_waitcnt lgkmcnt(12)
  v_mfma_f32_16x16x32_bf16 v[24:27], v[120:123], v[20:23], v[24:27]
  s_waitcnt lgkmcnt(10)
  v_mfma_f32_16x16x32_bf16 v[24:27], v[124:127], v[20:23], v[24:27]
  s_waitcnt lgkmcnt(8)
  v_mfma_f32_16x16x32_bf16 v[24:27], v[128:131], v[20:23], v[24:27]
  s_waitcnt lgkmcnt(6)
  v_mfma_f32_16x16x32_bf16 v[24:27], v[132:135], v[20:23], v[24:27]
  s_mul_i32 s56, s86, 114688
  s_add_u32 s56, s56, 2097152
  s_mul_i32 s62, s44, 3584
  v_add_u32 v12, s62, v14
  s_lshl_b32 s57, s86, 3
  s_add_u32 s57, s57, s44
  s_mul_i32 s57, s57, 1792
  s_add_u32 s57, s57, 4194304
  v_mov_b32 v60, 0
  v_mov_b32 v61, 0
  v_mov_b32 v62, 0
  v_mov_b32 v63, 0
  v_and_b32 v8, 1, v2
  v_mul_u32_u24 v8, 57344, v8
  v_lshrrev_b32 v10, 1, v2
  s_and_b32 s55, s44, 1
  s_lshl_b32 s55, s55, 1
  v_add_u32 v10, s55, v10
  v_lshl_add_u32 v8, v10, 8, v8
  v_lshl_add_u32 v13, v3, 4, v8
  s_mul_i32 s58, s86, 448
  s_lshl_b32 s55, s87, 2
  s_add_u32 s58, s58, s55
  s_lshr_b32 s55, s44, 1
  s_add_u32 s58, s58, s55
  s_lshl_b32 s58, s58, 10
  s_add_u32 s58, s58, 8388608
  s_mov_b32 s59, 0xbfb8aa3b
  s_lshl_b32 s60, s86, 7
  s_add_u32 s60, s60, 16785408
  s_lshl_b32 s61, s86, 8
  s_lshl_b32 s55, s87, 2
  s_add_u32 s61, s61, s55
  s_add_u32 s61, s61, 16793600
  s_lshl_b32 s63, s44, 12
  s_lshr_b32 s55, s84, 1
  s_lshl_b32 s67, s55, 8
  s_add_u32 s67, s67, 16793600
  s_lshl_b32 s70, s55, 7
  s_lshl_b32 s55, s55, 3
  s_and_b32 s64, s84, 1
  s_add_u32 s55, s55, s64
  s_add_u32 s70, s70, s64
  s_mul_i32 s70, s70, 896
  s_lshl_b32 s64, s85, 7
  s_add_u32 s70, s70, s64
  s_mul_i32 s68, s55, 56
  s_mul_i32 s64, s44, 7
  s_add_u32 s68, s68, s64
  s_lshl_b32 s68, s68, 10
  s_add_u32 s68, s68, 8388608
  s_and_b32 s64, s44, 6
  s_add_u32 s55, s55, s64
  s_mul_i32 s69, s55, 14
  s_lshl_b32 s64, s85, 1
  s_add_u32 s69, s69, s64
  s_and_b32 s64, s44, 1
  s_add_u32 s69, s69, s64
  s_lshl_b32 s69, s69, 10
  s_add_u32 s69, s69, 2097152
  v_and_b32 v6, 1, v2
  v_lshl_add_u32 v6, v6, 2, v4
  v_and_b32 v7, 6, v6
  v_lshrrev_b32 v10, 1, v5
  v_xor_b32 v7, v7, v10
  v_lshrrev_b32 v10, 1, v2
  v_lshl_add_u32 v6, v10, 4, v6
  v_lshlrev_b32 v6, 7, v6
  v_lshl_add_u32 v6, v7, 4, v6
  v_and_b32 v7, 1, v5
  v_lshl_add_u32 v6, v7, 3, v6
  s_add_u32 s55, s63, 65536
  v_add_u32 v8, s55, v6
  v_xor_b32 v9, 32, v8
  v_xor_b32 v10, 64, v8
  v_xor_b32 v11, 96, v8
  s_waitcnt lgkmcnt(0)
  s_cmp_lg_u32 s44, 0
  s_cbranch_scc1 Lskip_15
  v_lshlrev_b32 v7, 2, v1
  s_mov_b32 exec_lo, 0x3fff
  s_mov_b32 exec_hi, 0x0
  s_mov_b32 s3, 400000
Lpoll_16:
  buffer_load_dword v6, v7, s[36:39], s60 offen sc1
  s_waitcnt vmcnt(0)
  v_cmp_ne_u32 vcc, s47, v6
  s_sub_u32 s3, s3, 1
  s_cbranch_scc1 Ldone_17
  s_nop 1
  s_cmp_lg_u64 vcc, 0
  s_cbranch_scc1 Lpoll_16
Ldone_17:
  s_mov_b64 exec, -1
Lskip_15:
  s_barrier
  buffer_load_dwordx4 v[56:59], v14, s[36:39], s57 offen sc1
  s_mov_b32 exec_hi, 0xffff
  buffer_load_dwordx4 v[60:63], v14, s[36:39], s57 offen offset:1024 sc1
  s_mov_b64 exec, -1
  s_add_u32 s64, s56, 0
  s_add_u32 m0, s62, 0
  s_nop 0
  buffer_load_dwordx4 v12, s[36:39], s64 offen offset:0 sc1 lds
  s_add_u32 m0, s62, 0
  s_nop 0
  buffer_load_dwordx4 v12, s[36:39], s64 offen offset:1024 sc1 lds
  s_add_u32 m0, s62, 0
  s_nop 0
  buffer_load_dwordx4 v12, s[36:39], s64 offen offset:2048 sc1 lds
  s_add_u32 m0, s62, 0
  s_mov_b32 exec_hi, 0
  buffer_load_dwordx4 v12, s[36:39], s64 offen offset:3072 sc1 lds
  s_mov_b64 exec, -1
  s_waitcnt vmcnt(6)
  s_barrier
  ds_read_b64_tr_b16 v[148:149], v18 offset:0
  ds_read_b64_tr_b16 v[150:151], v18 offset:1024
  ds_read_b64_tr_b16 v[152:153], v18 offset:8192
  ds_read_b64_tr_b16 v[154:155], v18 offset:9216
  ds_read_b64_tr_b16 v[156:157], v18 offset:16384
  ds_read_b64_tr_b16 v[158:159], v18 offset:17408
  ds_read_b64_tr_b16 v[160:161], v18 offset:24576
  ds_read_b64_tr_b16 v[162:163], v18 offset:25600
  ds_read_b64_tr_b16 v[164:165], v18 offset:32768
  ds_read_b64_tr_b16 v[166:167], v18 offset:33792
  ds_read_b64_tr_b16 v[168:169], v18 offset:40960
  ds_read_b64_tr_b16 v[170:171], v18 offset:41984
  ds_read_b64_tr_b16 v[172:173], v18 offset:49152
  ds_read_b64_tr_b16 v[174:175], v18 offset:50176
  ds_read_b64_tr_b16 v[176:177], v19 offset:0
  ds_read_b64_tr_b16 v[178:179], v19 offset:1024
  ds_read_b64_tr_b16 v[180:181], v19 offset:8192
  ds_read_b64_tr_b16 v[182:183], v19 offset:9216
  ds_read_b64_tr_b16 v[184:185], v19 offset:16384
  ds_read_b64_tr_b16 v[186:187], v19 offset:17408
  ds_read_b64_tr_b16 v[188:189], v19 offset:40960
  ds_read_b64_tr_b16 v[190:191], v19 offset:41984
  v_lshrrev_b32 v6, 3, v1
  v_and_b32 v7, 7, v1
  v_and_b32 v16, 6, v6
  v_xor_b32 v7, v16, v7
  v_and_b32 v16, 3, v6
  v_lshrrev_b32 v6, 2, v6
  v_lshl_add_u32 v16, v6, 3, v16
  s_mul_i32 s55, s44, 224
  v_add_u32 v16, s55, v16
  v_mul_u32_u24 v16, 896, v16
  v_lshl_add_u32 v16, v7, 4, v16
  s_lshl_b32 s55, s85, 7
  v_add_u32 v17, s55, v16
  v_add_u32 v16, 57344, v14
  v_lshlrev_b32 v19, 4, v3
  v_add_u32 v19, 149504, v19
  s_lshl_b32 s55, s44, 8
  s_add_u32 s55, s55, 149504
  v_and_b32 v18, 7, v1
  v_lshl_add_u32 v18, v18, 5, s55
  v_mfma_f32_16x16x32_bf16 v[28:31], v[136:139], v[20:23], 0
  v_mfma_f32_16x16x32_bf16 v[28:31], v[140:143], v[20:23], v[28:31]
  v_mfma_f32_16x16x32_bf16 v[28:31], v[144:147], v[20:23], v[28:31]
  s_waitcnt lgkmcnt(15)
  v_mfma_f32_16x16x32_bf16 v[28:31], v[148:151], v[20:23], v[28:31]
  v_mfma_f32_16x16x32_bf16 v[28:31], v[152:155], v[20:23], v[28:31]
  v_mfma_f32_16x16x32_bf16 v[28:31], v[156:159], v[20:23], v[28:31]
  s_waitcnt lgkmcnt(14)
  v_mfma_f32_16x16x32_bf16 v[28:31], v[160:163], v[20:23], v[28:31]
  s_waitcnt lgkmcnt(12)
  v_mfma_f32_16x16x32_bf16 v[28:31], v[164:167], v[20:23], v[28:31]
  s_waitcnt lgkmcnt(10)
  v_mfma_f32_16x16x32_bf16 v[28:31], v[168:171], v[20:23], v[28:31]
  s_waitcnt lgkmcnt(8)
  v_mfma_f32_16x16x32_bf16 v[28:31], v[172:175], v[20:23], v[28:31]
  s_waitcnt lgkmcnt(6)
  v_mfma_f32_16x16x32_bf16 v[28:31], v[176:179], v[20:23], v[28:31]
  s_waitcnt lgkmcnt(4)
  v_mfma_f32_16x16x32_bf16 v[28:31], v[180:183], v[20:23], v[28:31]
  s_waitcnt lgkmcnt(2)
  v_mfma_f32_16x16x32_bf16 v[28:31], v[184:187], v[20:23], v[28:31]
  s_waitcnt lgkmcnt(0)
  v_mfma_f32_16x16x32_bf16 v[28:31], v[188:191], v[20:23], v[28:31]
  s_waitcnt vmcnt(4)
  v_add_f32 v56, v56, v60
  v_add_f32 v57, v57, v61
  v_add_f32 v58, v58, v62
  v_add_f32 v59, v59, v63
  v_add_f32_dpp v56, v56, v56 row_ror:8 row_mask:0xf bank_mask:0xf
  v_add_f32_dpp v57, v57, v57 row_ror:8 row_mask:0xf bank_mask:0xf
  v_add_f32_dpp v58, v58, v58 row_ror:8 row_mask:0xf bank_mask:0xf
  v_add_f32_dpp v59, v59, v59 row_ror:8 row_mask:0xf bank_mask:0xf
  v_mov_b32 v60, v56
  v_mov_b32 v61, v57
  v_mov_b32 v62, v58
  v_mov_b32 v63, v59
  v_permlane32_swap_b32 v60, v56
  v_permlane32_swap_b32 v61, v57
  v_permlane32_swap_b32 v62, v58
  v_permlane32_swap_b32 v63, v59
  v_add_f32 v56, v56, v60
  v_add_f32 v57, v57, v61
  v_add_f32 v58, v58, v62
  v_add_f32 v59, v59, v63
  v_mov_b32 v60, v56
  v_mov_b32 v61, v57
  v_mov_b32 v62, v58
  v_mov_b32 v63, v59
  v_permlane16_swap_b32 v60, v56
  v_permlane16_swap_b32 v61, v57
  v_permlane16_swap_b32 v62, v58
  v_permlane16_swap_b32 v63, v59
  v_add_f32 v56, v56, v60
  v_add_f32 v57, v57, v61
  v_add_f32 v58, v58, v62
  v_add_f32 v59, v59, v63
  s_mov_b32 s55, 0x3b124925
  v_mov_b32 v6, 0x3727c5ac
  v_mul_f32 v32, -s55, v56
  v_fma_f32 v57, v57, s55, v6
  v_fma_f32 v57, -v32, v32, v57
  v_max_f32 v57, v57, v6
  v_sqrt_f32 v34, v57
  v_rsq_f32 v57, v57
  s_nop 0
  v_mul_f32 v33, s59, v57
  v_mul_f32 v36, -s55, v58
  v_fma_f32 v59, v59, s55, v6
  v_fma_f32 v59, -v36, v36, v59
  v_max_f32 v59, v59, v6
  v_sqrt_f32 v38, v59
  v_rsq_f32 v59, v59
  s_nop 0
  v_mul_f32 v37, s59, v59
  ds_write_b128 v18, v[32:35]
  ds_write_b128 v18, v[36:39] offset:16
  s_waitcnt vmcnt(0) lgkmcnt(0)
  s_barrier
  s_setprio 3
  ds_read_b128 v[192:195], v14 offset:0
  ds_read_b128 v[196:199], v14 offset:1024
  ds_read_b128 v[200:203], v14 offset:2048
  ds_read_b128 v[204:207], v14 offset:3072
  ds_read_b128 v[208:211], v14 offset:4096
  ds_read_b128 v[212:215], v14 offset:5120
  s_waitcnt lgkmcnt(5)
  v_mfma_f32_16x16x32_bf16 v[40:43], v[80:83], v[192:195], 0
  v_mfma_f32_16x16x32_bf16 v[44:47], v[136:139], v[192:195], 0
  s_add_u32 s64, s56, 28672
  s_add_u32 m0, s62, 28672
  s_nop 0
  buffer_load_dwordx4 v12, s[36:39], s64 offen offset:0 sc1 lds
  ds_read_b128 v[216:219], v14 offset:6144
  s_waitcnt lgkmcnt(5)
  v_mfma_f32_16x16x32_bf16 v[40:43], v[84:87], v[196:199], v[40:43]
  v_mfma_f32_16x16x32_bf16 v[44:47], v[140:143], v[196:199], v[44:47]
  s_add_u32 m0, s62, 28672
  s_nop 0
  buffer_load_dwordx4 v12, s[36:39], s64 offen offset:1024 sc1 lds
  ds_read_b128 v[220:223], v14 offset:7168
  s_waitcnt lgkmcnt(5)
  v_mfma_f32_16x16x32_bf16 v[40:43], v[88:91], v[200:203], v[40:43]
  v_mfma_f32_16x16x32_bf16 v[44:47], v[144:147], v[200:203], v[44:47]
  s_add_u32 m0, s62, 28672
  s_nop 0
  buffer_load_dwordx4 v12, s[36:39], s64 offen offset:2048 sc1 lds
  ds_read_b128 v[192:195], v14 offset:8192
  s_waitcnt lgkmcnt(5)
  v_mfma_f32_16x16x32_bf16 v[40:43], v[92:95], v[204:207], v[40:43]
  v_mfma_f32_16x16x32_bf16 v[44:47], v[148:151], v[204:207], v[44:47]
  s_add_u32 m0, s62, 28672
  s_mov_b32 exec_hi, 0
  buffer_load_dwordx4 v12, s[36:39], s64 offen offset:3072 sc1 lds
  s_mov_b64 exec, -1
  ds_read_b128 v[196:199], v14 offset:9216
  s_waitcnt lgkmcnt(5)
  v_mfma_f32_16x16x32_bf16 v[40:43], v[96:99], v[208:211], v[40:43]
  v_mfma_f32_16x16x32_bf16 v[44:47], v[152:155], v[208:211], v[44:47]
  s_setprio 2
  ds_read_b128 v[200:203], v14 offset:10240
  s_waitcnt lgkmcnt(5)
  v_mfma_f32_16x16x32_bf16 v[40:43], v[100:103], v[212:215], v[40:43]
  v_mfma_f32_16x16x32_bf16 v[44:47], v[156:159], v[212:215], v[44:47]
  s_add_u32 s64, s56, 57344
  s_add_u32 m0, s62, 57344
  s_nop 0
  buffer_load_dwordx4 v12, s[36:39], s64 offen offset:0 sc1 lds
  ds_read_b128 v[204:207], v14 offset:11264
  s_waitcnt lgkmcnt(5)
  v_mfma_f32_16x16x32_bf16 v[40:43], v[104:107], v[216:219], v[40:43]
  v_mfma_f32_16x16x32_bf16 v[44:47], v[160:163], v[216:219], v[44:47]
  ds_read_b128 v[208:211], v14 offset:12288
  s_waitcnt lgkmcnt(5)
  v_mfma_f32_16x16x32_bf16 v[40:43], v[108:111], v[220:223], v[40:43]
  v_mfma_f32_16x16x32_bf16 v[44:47], v[164:167], v[220:223], v[44:47]
  s_add_u32 m0, s62, 57344
  s_nop 0
  buffer_load_dwordx4 v12, s[36:39], s64 offen offset:1024 sc1 lds
  ds_read_b128 v[212:215], v14 offset:13312
  s_waitcnt lgkmcnt(5)
  v_mfma_f32_16x16x32_bf16 v[40:43], v[112:115], v[192:195], v[40:43]
  v_mfma_f32_16x16x32_bf16 v[44:47], v[168:171], v[192:195], v[44:47]
  ds_read_b128 v[216:219], v14 offset:14336
  s_waitcnt lgkmcnt(5)
  v_mfma_f32_16x16x32_bf16 v[40:43], v[116:119], v[196:199], v[40:43]
  v_mfma_f32_16x16x32_bf16 v[44:47], v[172:175], v[196:199], v[44:47]
  s_add_u32 m0, s62, 57344
  s_nop 0
  buffer_load_dwordx4 v12, s[36:39], s64 offen offset:2048 sc1 lds
  ds_read_b128 v[220:223], v14 offset:15360
  s_waitcnt lgkmcnt(5)
  v_mfma_f32_16x16x32_bf16 v[40:43], v[120:123], v[200:203], v[40:43]
  v_mfma_f32_16x16x32_bf16 v[44:47], v[176:179], v[200:203], v[44:47]
  s_setprio 1
  ds_read_b128 v[192:195], v14 offset:16384
  s_waitcnt lgkmcnt(5)
  v_mfma_f32_16x16x32_bf16 v[40:43], v[124:127], v[204:207], v[40:43]
  v_mfma_f32_16x16x32_bf16 v[44:47], v[180:183], v[204:207], v[44:47]
  s_add_u32 m0, s62, 57344
  s_mov_b32 exec_hi, 0
  buffer_load_dwordx4 v12, s[36:39], s64 offen offset:3072 sc1 lds
  s_mov_b64 exec, -1
  ds_read_b128 v[196:199], v14 offset:17408
  s_waitcnt lgkmcnt(5)
  v_mfma_f32_16x16x32_bf16 v[40:43], v[128:131], v[208:211], v[40:43]
  v_mfma_f32_16x16x32_bf16 v[44:47], v[184:187], v[208:211], v[44:47]
  ds_read_b128 v[200:203], v14 offset:18432
  s_waitcnt lgkmcnt(5)
  v_mfma_f32_16x16x32_bf16 v[40:43], v[132:135], v[212:215], v[40:43]
  v_mfma_f32_16x16x32_bf16 v[44:47], v[188:191], v[212:215], v[44:47]
  s_add_u32 s64, s56, 86016
  s_add_u32 m0, s62, 86016
  s_nop 0
  buffer_load_dwordx4 v12, s[36:39], s64 offen offset:0 sc1 lds
  ds_read_b128 v[204:207], v14 offset:19456
  s_waitcnt lgkmcnt(5)
  v_mfma_f32_16x16x32_bf16 v[48:51], v[80:83], v[216:219], 0
  ds_read_b128 v[32:35], v19 offset:0
  v_mfma_f32_16x16x32_bf16 v[52:55], v[136:139], v[216:219], 0
  s_waitcnt lgkmcnt(0)
  v_fmac_f32 v40, v32, v24
  v_fmac_f32 v41, v32, v25
  ds_read_b128 v[208:211], v14 offset:20480
  v_mfma_f32_16x16x32_bf16 v[48:51], v[84:87], v[220:223], v[48:51]
  v_fmac_f32 v42, v32, v26
  v_fmac_f32 v43, v32, v27
  v_mfma_f32_16x16x32_bf16 v[52:55], v[140:143], v[220:223], v[52:55]
  v_mul_f32 v40, v33, v40
  v_mul_f32 v41, v33, v41
  v_mul_f32 v42, v33, v42
  s_add_u32 m0, s62, 86016
  s_nop 0
  buffer_load_dwordx4 v12, s[36:39], s64 offen offset:1024 sc1 lds
  s_setprio 0
  ds_read_b128 v[212:215], v14 offset:21504
  v_mfma_f32_16x16x32_bf16 v[48:51], v[88:91], v[192:195], v[48:51]
  v_mul_f32 v43, v33, v43
  v_exp_f32 v40, v40
  v_mfma_f32_16x16x32_bf16 v[52:55], v[144:147], v[192:195], v[52:55]
  v_exp_f32 v41, v41
  v_exp_f32 v42, v42
  v_exp_f32 v43, v43
  ds_read_b128 v[216:219], v14 offset:22528
  v_mfma_f32_16x16x32_bf16 v[48:51], v[92:95], v[196:199], v[48:51]
  v_fmac_f32 v44, v32, v28
  v_fmac_f32 v45, v32, v29
  v_mfma_f32_16x16x32_bf16 v[52:55], v[148:151], v[196:199], v[52:55]
  v_fmac_f32 v46, v32, v30
  v_fmac_f32 v47, v32, v31
  v_fma_f32 v40, v40, v34, v34
  s_add_u32 m0, s62, 86016
  s_nop 0
  buffer_load_dwordx4 v12, s[36:39], s64 offen offset:2048 sc1 lds
  ds_read_b128 v[220:223], v14 offset:23552
  v_mfma_f32_16x16x32_bf16 v[48:51], v[96:99], v[200:203], v[48:51]
  v_fma_f32 v41, v41, v34, v34
  v_fma_f32 v42, v42, v34, v34
  v_mfma_f32_16x16x32_bf16 v[52:55], v[152:155], v[200:203], v[52:55]
  v_fma_f32 v43, v43, v34, v34
  v_rcp_f32 v40, v40
  v_rcp_f32 v41, v41
  ds_read_b128 v[192:195], v14 offset:24576
  v_mfma_f32_16x16x32_bf16 v[48:51], v[100:103], v[204:207], v[48:51]
  v_rcp_f32 v42, v42
  v_rcp_f32 v43, v43
  v_mfma_f32_16x16x32_bf16 v[52:55], v[156:159], v[204:207], v[52:55]
  v_mul_f32 v40, v40, v44
  v_mul_f32 v41, v41, v45
  v_mul_f32 v42, v42, v46
  s_add_u32 m0, s62, 86016
  s_mov_b32 exec_hi, 0
  buffer_load_dwordx4 v12, s[36:39], s64 offen offset:3072 sc1 lds
  s_mov_b64 exec, -1
  ds_read_b128 v[196:199], v14 offset:25600
  s_waitcnt lgkmcnt(5)
  v_mfma_f32_16x16x32_bf16 v[48:51], v[104:107], v[208:211], v[48:51]
  v_mul_f32 v43, v43, v47
  v_cvt_pk_bf16_f32 v56, v40, v41
  v_mfma_f32_16x16x32_bf16 v[52:55], v[160:163], v[208:211], v[52:55]
  v_cvt_pk_bf16_f32 v57, v42, v43
  ds_read_b128 v[200:203], v14 offset:26624
  s_waitcnt lgkmcnt(5)
  v_mfma_f32_16x16x32_bf16 v[48:51], v[108:111], v[212:215], v[48:51]
  v_mfma_f32_16x16x32_bf16 v[52:55], v[164:167], v[212:215], v[52:55]
  s_waitcnt vmcnt(8)
  s_barrier
  s_setprio 3
  ds_read_b128 v[204:207], v14 offset:27648
  s_waitcnt lgkmcnt(5)
  v_mfma_f32_16x16x32_bf16 v[48:51], v[112:115], v[216:219], v[48:51]
  v_mfma_f32_16x16x32_bf16 v[52:55], v[168:171], v[216:219], v[52:55]
  s_add_u32 m0, s63, 116736
  s_mov_b32 s65, 0
  buffer_load_dwordx4 v17, s[28:31], s65 offen lds
  ds_read_b128 v[208:211], v14 offset:28672
  s_waitcnt lgkmcnt(5)
  v_mfma_f32_16x16x32_bf16 v[48:51], v[116:119], v[220:223], v[48:51]
  v_mfma_f32_16x16x32_bf16 v[52:55], v[172:175], v[220:223], v[52:55]
  s_add_u32 m0, s63, 117760
  s_mov_b32 s65, 3584
  buffer_load_dwordx4 v17, s[28:31], s65 offen lds
  ds_read_b128 v[212:215], v14 offset:29696
  s_waitcnt lgkmcnt(5)
  v_mfma_f32_16x16x32_bf16 v[48:51], v[120:123], v[192:195], v[48:51]
  v_mfma_f32_16x16x32_bf16 v[52:55], v[176:179], v[192:195], v[52:55]
  s_add_u32 m0, s63, 118784
  s_mov_b32 s65, 14336
  buffer_load_dwordx4 v17, s[28:31], s65 offen lds
  ds_read_b128 v[216:219], v14 offset:30720
  s_waitcnt lgkmcnt(5)
  v_mfma_f32_16x16x32_bf16 v[48:51], v[124:127], v[196:199], v[48:51]
  v_mfma_f32_16x16x32_bf16 v[52:55], v[180:183], v[196:199], v[52:55]
  s_add_u32 m0, s63, 119808
  s_mov_b32 s65, 17920
  buffer_load_dwordx4 v17, s[28:31], s65 offen lds
  ds_read_b128 v[220:223], v14 offset:31744
  s_waitcnt lgkmcnt(5)
  v_mfma_f32_16x16x32_bf16 v[48:51], v[128:131], v[200:203], v[48:51]
  v_mfma_f32_16x16x32_bf16 v[52:55], v[184:187], v[200:203], v[52:55]
  ds_read_b128 v[192:195], v14 offset:32768
  s_waitcnt lgkmcnt(5)
  v_mfma_f32_16x16x32_bf16 v[48:51], v[132:135], v[204:207], v[48:51]
  v_mfma_f32_16x16x32_bf16 v[52:55], v[188:191], v[204:207], v[52:55]
  ds_read_b128 v[196:199], v14 offset:33792
  s_waitcnt lgkmcnt(5)
  v_mfma_f32_16x16x32_bf16 v[40:43], v[80:83], v[208:211], 0
  ds_read_b128 v[36:39], v19 offset:256
  v_mfma_f32_16x16x32_bf16 v[44:47], v[136:139], v[208:211], 0
  s_waitcnt lgkmcnt(0)
  s_nop 0
  v_fmac_f32 v48, v36, v24
  v_fmac_f32 v49, v36, v25
  s_setprio 2
  ds_read_b128 v[200:203], v14 offset:34816
  v_mfma_f32_16x16x32_bf16 v[40:43], v[84:87], v[212:215], v[40:43]
  v_fmac_f32 v50, v36, v26
  v_fmac_f32 v51, v36, v27
  v_mfma_f32_16x16x32_bf16 v[44:47], v[140:143], v[212:215], v[44:47]
  v_mul_f32 v48, v37, v48
  v_mul_f32 v49, v37, v49
  v_mul_f32 v50, v37, v50
  ds_read_b128 v[204:207], v14 offset:35840
  v_mfma_f32_16x16x32_bf16 v[40:43], v[88:91], v[216:219], v[40:43]
  v_mul_f32 v51, v37, v51
  v_exp_f32 v48, v48
  v_mfma_f32_16x16x32_bf16 v[44:47], v[144:147], v[216:219], v[44:47]
  v_exp_f32 v49, v49
  v_exp_f32 v50, v50
  v_exp_f32 v51, v51
  ds_read_b128 v[208:211], v14 offset:36864
  v_mfma_f32_16x16x32_bf16 v[40:43], v[92:95], v[220:223], v[40:43]
  v_fmac_f32 v52, v36, v28
  v_fmac_f32 v53, v36, v29
  v_mfma_f32_16x16x32_bf16 v[44:47], v[148:151], v[220:223], v[44:47]
  v_fmac_f32 v54, v36, v30
  v_fmac_f32 v55, v36, v31
  v_fma_f32 v48, v48, v38, v38
  ds_read_b128 v[212:215], v14 offset:37888
  v_mfma_f32_16x16x32_bf16 v[40:43], v[96:99], v[192:195], v[40:43]
  v_fma_f32 v49, v49, v38, v38
  v_fma_f32 v50, v50, v38, v38
  v_mfma_f32_16x16x32_bf16 v[44:47], v[152:155], v[192:195], v[44:47]
  v_fma_f32 v51, v51, v38, v38
  v_rcp_f32 v48, v48
  v_rcp_f32 v49, v49
  ds_read_b128 v[216:219], v14 offset:38912
  v_mfma_f32_16x16x32_bf16 v[40:43], v[100:103], v[196:199], v[40:43]
  v_rcp_f32 v50, v50
  v_rcp_f32 v51, v51
  v_mfma_f32_16x16x32_bf16 v[44:47], v[156:159], v[196:199], v[44:47]
  v_mul_f32 v48, v48, v52
  v_mul_f32 v49, v49, v53
  v_mul_f32 v50, v50, v54
  ds_read_b128 v[220:223], v14 offset:39936
  s_waitcnt lgkmcnt(5)
  v_mfma_f32_16x16x32_bf16 v[40:43], v[104:107], v[200:203], v[40:43]
  v_mul_f32 v51, v51, v55
  v_cvt_pk_bf16_f32 v58, v48, v49
  v_mfma_f32_16x16x32_bf16 v[44:47], v[160:163], v[200:203], v[44:47]
  v_cvt_pk_bf16_f32 v59, v50, v51
  v_permlane16_swap_b32 v56, v58
  s_nop 0
  v_permlane16_swap_b32 v57, v59
  ds_read_b128 v[192:195], v14 offset:40960
  s_waitcnt lgkmcnt(5)
  v_mfma_f32_16x16x32_bf16 v[40:43], v[108:111], v[204:207], v[40:43]
  buffer_store_dwordx4 v[56:59], v13, s[36:39], s58 offen sc1
  s_add_u32 s58, s58, 114688
  v_mfma_f32_16x16x32_bf16 v[44:47], v[164:167], v[204:207], v[44:47]
  s_setprio 1
  ds_read_b128 v[196:199], v14 offset:41984
  s_waitcnt lgkmcnt(5)
  v_mfma_f32_16x16x32_bf16 v[40:43], v[112:115], v[208:211], v[40:43]
  v_mfma_f32_16x16x32_bf16 v[44:47], v[168:171], v[208:211], v[44:47]
  ds_read_b128 v[200:203], v14 offset:43008
  s_waitcnt lgkmcnt(5)
  v_mfma_f32_16x16x32_bf16 v[40:43], v[116:119], v[212:215], v[40:43]
  v_mfma_f32_16x16x32_bf16 v[44:47], v[172:175], v[212:215], v[44:47]
  ds_read_b128 v[204:207], v14 offset:44032
  s_waitcnt lgkmcnt(5)
  v_mfma_f32_16x16x32_bf16 v[40:43], v[120:123], v[216:219], v[40:43]
  v_mfma_f32_16x16x32_bf16 v[44:47], v[176:179], v[216:219], v[44:47]
  s_waitcnt vmcnt(1)
  ds_read_b64_tr_b16 v[224:225], v8 offset:51200
  ds_read_b64_tr_b16 v[226:227], v8 offset:52224
  ds_read_b64_tr_b16 v[228:229], v9 offset:51200
  ds_read_b64_tr_b16 v[230:231], v9 offset:52224
  ds_read_b64_tr_b16 v[232:233], v10 offset:51200
  ds_read_b64_tr_b16 v[234:235], v10 offset:52224
  ds_read_b64_tr_b16 v[236:237], v11 offset:51200
  ds_read_b64_tr_b16 v[238:239], v11 offset:52224
  ds_read_b128 v[208:211], v14 offset:45056
  s_waitcnt lgkmcnt(13)
  v_mfma_f32_16x16x32_bf16 v[40:43], v[124:127], v[220:223], v[40:43]
  v_mfma_f32_16x16x32_bf16 v[44:47], v[180:183], v[220:223], v[44:47]
  ds_read_b128 v[212:215], v14 offset:46080
  s_waitcnt lgkmcnt(13)
  v_mfma_f32_16x16x32_bf16 v[40:43], v[128:131], v[192:195], v[40:43]
  v_mfma_f32_16x16x32_bf16 v[44:47], v[184:187], v[192:195], v[44:47]
  ds_read_b128 v[216:219], v14 offset:47104
  s_waitcnt lgkmcnt(13)
  v_mfma_f32_16x16x32_bf16 v[40:43], v[132:135], v[196:199], v[40:43]
  v_mfma_f32_16x16x32_bf16 v[44:47], v[188:191], v[196:199], v[44:47]
  ds_read_b128 v[220:223], v14 offset:48128
  s_waitcnt lgkmcnt(13)
  v_mfma_f32_16x16x32_bf16 v[48:51], v[80:83], v[200:203], 0
  ds_read_b128 v[32:35], v19 offset:512
  v_mfma_f32_16x16x32_bf16 v[52:55], v[136:139], v[200:203], 0
  s_waitcnt lgkmcnt(0)
  s_nop 0
  v_fmac_f32 v40, v32, v24
  v_fmac_f32 v41, v32, v25
  s_setprio 0
  ds_read_b128 v[192:195], v14 offset:49152
  v_mfma_f32_16x16x32_bf16 v[48:51], v[84:87], v[204:207], v[48:51]
  v_fmac_f32 v42, v32, v26
  v_fmac_f32 v43, v32, v27
  v_mfma_f32_16x16x32_bf16 v[52:55], v[140:143], v[204:207], v[52:55]
  v_mul_f32 v40, v33, v40
  v_mul_f32 v41, v33, v41
  v_mul_f32 v42, v33, v42
  ds_read_b128 v[196:199], v14 offset:50176
  v_mfma_f32_16x16x32_bf16 v[48:51], v[88:91], v[208:211], v[48:51]
  v_mul_f32 v43, v33, v43
  v_exp_f32 v40, v40
  v_mfma_f32_16x16x32_bf16 v[52:55], v[144:147], v[208:211], v[52:55]
  v_exp_f32 v41, v41
  v_exp_f32 v42, v42
  v_exp_f32 v43, v43
  s_add_u32 m0, s63, 116736
  s_mov_b32 s65, 28672
  buffer_load_dwordx4 v17, s[28:31], s65 offen lds
  ds_read_b128 v[200:203], v14 offset:51200
  v_mfma_f32_16x16x32_bf16 v[48:51], v[92:95], v[212:215], v[48:51]
  v_fmac_f32 v44, v32, v28
  v_fmac_f32 v45, v32, v29
  v_mfma_f32_16x16x32_bf16 v[52:55], v[148:151], v[212:215], v[52:55]
  v_fmac_f32 v46, v32, v30
  v_fmac_f32 v47, v32, v31
  v_fma_f32 v40, v40, v34, v34
  s_add_u32 m0, s63, 117760
  s_mov_b32 s65, 32256
  buffer_load_dwordx4 v17, s[28:31], s65 offen lds
  ds_read_b128 v[204:207], v14 offset:52224
  v_mfma_f32_16x16x32_bf16 v[48:51], v[96:99], v[216:219], v[48:51]
  v_fma_f32 v41, v41, v34, v34
  v_fma_f32 v42, v42, v34, v34
  v_mfma_f32_16x16x32_bf16 v[52:55], v[152:155], v[216:219], v[52:55]
  v_fma_f32 v43, v43, v34, v34
  v_rcp_f32 v40, v40
  v_rcp_f32 v41, v41
  s_add_u32 m0, s63, 118784
  s_mov_b32 s65, 43008
  buffer_load_dwordx4 v17, s[28:31], s65 offen lds
  ds_read_b128 v[208:211], v14 offset:53248
  v_mfma_f32_16x16x32_bf16 v[48:51], v[100:103], v[220:223], v[48:51]
  v_rcp_f32 v42, v42
  v_rcp_f32 v43, v43
  v_mfma_f32_16x16x32_bf16 v[52:55], v[156:159], v[220:223], v[52:55]
  v_mul_f32 v40, v40, v44
  v_mul_f32 v41, v41, v45
  v_mul_f32 v42, v42, v46
  s_add_u32 m0, s63, 119808
  s_mov_b32 s65, 46592
  buffer_load_dwordx4 v17, s[28:31], s65 offen lds
  ds_read_b128 v[212:215], v14 offset:54272
  s_waitcnt lgkmcnt(5)
  v_mfma_f32_16x16x32_bf16 v[48:51], v[104:107], v[192:195], v[48:51]
  v_mul_f32 v43, v43, v47
  v_cvt_pk_bf16_f32 v60, v40, v41
  v_mfma_f32_16x16x32_bf16 v[52:55], v[160:163], v[192:195], v[52:55]
  v_cvt_pk_bf16_f32 v61, v42, v43
  ds_read_b128 v[216:219], v14 offset:55296
  s_waitcnt lgkmcnt(5)
  v_mfma_f32_16x16x32_bf16 v[48:51], v[108:111], v[196:199], v[48:51]
  v_mfma_f32_16x16x32_bf16 v[52:55], v[164:167], v[196:199], v[52:55]
  s_waitcnt vmcnt(4)
  s_barrier
  s_cmp_lg_u32 s44, 0
  s_cbranch_scc1 Lpub_18
  s_mov_b64 exec, 1
  v_mov_b32 v6, s47
  v_mov_b32 v7, 0
  buffer_store_dword v6, v7, s[36:39], s61 offen sc1
  s_mov_b64 exec, -1
Lpub_18:
  s_add_u32 s61, s61, 64
  s_setprio 3
  ds_read_b128 v[220:223], v14 offset:56320
  s_waitcnt lgkmcnt(5)
  v_mfma_f32_16x16x32_bf16 v[48:51], v[112:115], v[200:203], v[48:51]
  v_mfma_f32_16x16x32_bf16 v[52:55], v[168:171], v[200:203], v[52:55]
  ds_read_b128 v[192:195], v16 offset:0
  s_waitcnt lgkmcnt(5)
  v_mfma_f32_16x16x32_bf16 v[48:51], v[116:119], v[204:207], v[48:51]
  v_mfma_f32_16x16x32_bf16 v[52:55], v[172:175], v[204:207], v[52:55]
  ds_read_b128 v[196:199], v16 offset:1024
  s_waitcnt lgkmcnt(5)
  v_mfma_f32_16x16x32_bf16 v[48:51], v[120:123], v[208:211], v[48:51]
  v_mfma_f32_16x16x32_bf16 v[52:55], v[176:179], v[208:211], v[52:55]
  s_add_u32 m0, s63, 0
  s_mov_b32 s65, 114688
  buffer_load_dwordx4 v17, s[28:31], s65 offen lds
  ds_read_b128 v[200:203], v16 offset:2048
  s_waitcnt lgkmcnt(5)
  v_mfma_f32_16x16x32_bf16 v[48:51], v[124:127], v[212:215], v[48:51]
  v_mfma_f32_16x16x32_bf16 v[52:55], v[180:183], v[212:215], v[52:55]
  ds_read_b128 v[204:207], v16 offset:3072
  s_waitcnt lgkmcnt(5)
  v_mfma_f32_16x16x32_bf16 v[48:51], v[128:131], v[216:219], v[48:51]
  v_mfma_f32_16x16x32_bf16 v[52:55], v[184:187], v[216:219], v[52:55]
  s_add_u32 m0, s63, 1024
  s_mov_b32 s65, 118272
  buffer_load_dwordx4 v17, s[28:31], s65 offen lds
  ds_read_b128 v[208:211], v16 offset:4096
  s_waitcnt lgkmcnt(5)
  v_mfma_f32_16x16x32_bf16 v[48:51], v[132:135], v[220:223], v[48:51]
  v_mfma_f32_16x16x32_bf16 v[52:55], v[188:191], v[220:223], v[52:55]
  ds_read_b128 v[212:215], v16 offset:5120
  s_waitcnt lgkmcnt(5)
  v_mfma_f32_16x16x32_bf16 v[40:43], v[80:83], v[192:195], 0
  ds_read_b128 v[36:39], v19 offset:768
  v_mfma_f32_16x16x32_bf16 v[44:47], v[136:139], v[192:195], 0
  s_waitcnt lgkmcnt(0)
  s_nop 0
  v_fmac_f32 v48, v36, v24
  v_fmac_f32 v49, v36, v25
  s_add_u32 m0, s63, 2048
  s_mov_b32 s65, 129024
  buffer_load_dwordx4 v17, s[28:31], s65 offen lds
  s_setprio 2
  ds_read_b128 v[216:219], v16 offset:6144
  v_mfma_f32_16x16x32_bf16 v[40:43], v[84:87], v[196:199], v[40:43]
  v_fmac_f32 v50, v36, v26
  v_fmac_f32 v51, v36, v27
  v_mfma_f32_16x16x32_bf16 v[44:47], v[140:143], v[196:199], v[44:47]
  v_mul_f32 v48, v37, v48
  v_mul_f32 v49, v37, v49
  v_mul_f32 v50, v37, v50
  ds_read_b128 v[220:223], v16 offset:7168
  v_mfma_f32_16x16x32_bf16 v[40:43], v[88:91], v[200:203], v[40:43]
  v_mul_f32 v51, v37, v51
  v_exp_f32 v48, v48
  v_mfma_f32_16x16x32_bf16 v[44:47], v[144:147], v[200:203], v[44:47]
  v_exp_f32 v49, v49
  v_exp_f32 v50, v50
  v_exp_f32 v51, v51
  s_add_u32 m0, s63, 3072
  s_mov_b32 s65, 132608
  buffer_load_dwordx4 v17, s[28:31], s65 offen lds
  ds_read_b128 v[192:195], v16 offset:8192
  v_mfma_f32_16x16x32_bf16 v[40:43], v[92:95], v[204:207], v[40:43]
  v_fmac_f32 v52, v36, v28
  v_fmac_f32 v53, v36, v29
  v_mfma_f32_16x16x32_bf16 v[44:47], v[148:151], v[204:207], v[44:47]
  v_fmac_f32 v54, v36, v30
  v_fmac_f32 v55, v36, v31
  v_fma_f32 v48, v48, v38, v38
  ds_read_b128 v[196:199], v16 offset:9216
  v_mfma_f32_16x16x32_bf16 v[40:43], v[96:99], v[208:211], v[40:43]
  v_fma_f32 v49, v49, v38, v38
  v_fma_f32 v50, v50, v38, v38
  v_mfma_f32_16x16x32_bf16 v[44:47], v[152:155], v[208:211], v[44:47]
  v_fma_f32 v51, v51, v38, v38
  v_rcp_f32 v48, v48
  v_rcp_f32 v49, v49
  ds_read_b128 v[200:203], v16 offset:10240
  v_mfma_f32_16x16x32_bf16 v[40:43], v[100:103], v[212:215], v[40:43]
  v_rcp_f32 v50, v50
  v_rcp_f32 v51, v51
  v_mfma_f32_16x16x32_bf16 v[44:47], v[156:159], v[212:215], v[44:47]
  v_mul_f32 v48, v48, v52
  v_mul_f32 v49, v49, v53
  v_mul_f32 v50, v50, v54
  ds_read_b128 v[204:207], v16 offset:11264
  s_waitcnt lgkmcnt(5)
  v_mfma_f32_16x16x32_bf16 v[40:43], v[104:107], v[216:219], v[40:43]
  v_mul_f32 v51, v51, v55
  v_cvt_pk_bf16_f32 v62, v48, v49
  v_mfma_f32_16x16x32_bf16 v[44:47], v[160:163], v[216:219], v[44:47]
  v_cvt_pk_bf16_f32 v63, v50, v51
  v_permlane16_swap_b32 v60, v62
  s_nop 0
  v_permlane16_swap_b32 v61, v63
  s_waitcnt vmcnt(4)
  ds_read_b64_tr_b16 v[240:241], v8 offset:51200
  ds_read_b64_tr_b16 v[242:243], v8 offset:52224
  ds_read_b64_tr_b16 v[244:245], v9 offset:51200
  ds_read_b64_tr_b16 v[246:247], v9 offset:52224
  ds_read_b64_tr_b16 v[248:249], v10 offset:51200
  ds_read_b64_tr_b16 v[250:251], v10 offset:52224
  ds_read_b64_tr_b16 v[252:253], v11 offset:51200
  ds_read_b64_tr_b16 v[254:255], v11 offset:52224
  ds_read_b128 v[208:211], v16 offset:12288
  s_waitcnt lgkmcnt(13)
  v_mfma_f32_16x16x32_bf16 v[40:43], v[108:111], v[220:223], v[40:43]
  buffer_store_dwordx4 v[60:63], v13, s[36:39], s58 offen sc1
  s_add_u32 s58, s58, 114688
  v_mfma_f32_16x16x32_bf16 v[44:47], v[164:167], v[220:223], v[44:47]
  s_setprio 1
  ds_read_b128 v[212:215], v16 offset:13312
  s_waitcnt lgkmcnt(13)
  v_mfma_f32_16x16x32_bf16 v[40:43], v[112:115], v[192:195], v[40:43]
  v_mfma_f32_16x16x32_bf16 v[44:47], v[168:171], v[192:195], v[44:47]
  ds_read_b128 v[216:219], v16 offset:14336
  s_waitcnt lgkmcnt(13)
  v_mfma_f32_16x16x32_bf16 v[40:43], v[116:119], v[196:199], v[40:43]
  v_mfma_f32_16x16x32_bf16 v[44:47], v[172:175], v[196:199], v[44:47]
  ds_read_b128 v[220:223], v16 offset:15360
  s_waitcnt lgkmcnt(13)
  v_mfma_f32_16x16x32_bf16 v[40:43], v[120:123], v[200:203], v[40:43]
  v_mfma_f32_16x16x32_bf16 v[44:47], v[176:179], v[200:203], v[44:47]
  ds_read_b128 v[192:195], v16 offset:16384
  s_waitcnt lgkmcnt(13)
  v_mfma_f32_16x16x32_bf16 v[40:43], v[124:127], v[204:207], v[40:43]
  v_mfma_f32_16x16x32_bf16 v[44:47], v[180:183], v[204:207], v[44:47]
  ds_read_b128 v[196:199], v16 offset:17408
  s_waitcnt lgkmcnt(5)
  v_mfma_f32_16x16x32_bf16 v[40:43], v[128:131], v[208:211], v[40:43]
  v_mfma_f32_16x16x32_bf16 v[44:47], v[184:187], v[208:211], v[44:47]
  s_add_u32 m0, s63, 116736
  s_mov_b32 s65, 57344
  buffer_load_dwordx4 v17, s[28:31], s65 offen lds
  ds_read_b128 v[200:203], v16 offset:18432
  s_waitcnt lgkmcnt(5)
  v_mfma_f32_16x16x32_bf16 v[40:43], v[132:135], v[212:215], v[40:43]
  v_mfma_f32_16x16x32_bf16 v[44:47], v[188:191], v[212:215], v[44:47]
  s_add_u32 m0, s63, 117760
  s_mov_b32 s65, 60928
  buffer_load_dwordx4 v17, s[28:31], s65 offen lds
  ds_read_b128 v[204:207], v16 offset:19456
  s_waitcnt lgkmcnt(5)
  v_mfma_f32_16x16x32_bf16 v[48:51], v[80:83], v[216:219], 0
  ds_read_b128 v[32:35], v19 offset:1024
  v_mfma_f32_16x16x32_bf16 v[52:55], v[136:139], v[216:219], 0
  s_waitcnt lgkmcnt(0)
  v_fmac_f32 v40, v32, v24
  v_fmac_f32 v41, v32, v25
  s_add_u32 m0, s63, 118784
  s_mov_b32 s65, 71680
  buffer_load_dwordx4 v17, s[28:31], s65 offen lds
  s_setprio 0
  ds_read_b128 v[208:211], v16 offset:20480
  v_mfma_f32_16x16x32_bf16 v[48:51], v[84:87], v[220:223], v[48:51]
  v_fmac_f32 v42, v32, v26
  v_fmac_f32 v43, v32, v27
  v_mfma_f32_16x16x32_bf16 v[52:55], v[140:143], v[220:223], v[52:55]
  v_mul_f32 v40, v33, v40
  v_mul_f32 v41, v33, v41
  v_mul_f32 v42, v33, v42
  s_add_u32 m0, s63, 119808
  s_mov_b32 s65, 75264
  buffer_load_dwordx4 v17, s[28:31], s65 offen lds
  ds_read_b128 v[212:215], v16 offset:21504
  v_mfma_f32_16x16x32_bf16 v[48:51], v[88:91], v[192:195], v[48:51]
  v_mul_f32 v43, v33, v43
  v_exp_f32 v40, v40
  v_mfma_f32_16x16x32_bf16 v[52:55], v[144:147], v[192:195], v[52:55]
  v_exp_f32 v41, v41
  v_exp_f32 v42, v42
  v_exp_f32 v43, v43
  ds_read_b128 v[216:219], v16 offset:22528
  v_mfma_f32_16x16x32_bf16 v[48:51], v[92:95], v[196:199], v[48:51]
  v_fmac_f32 v44, v32, v28
  v_fmac_f32 v45, v32, v29
  v_mfma_f32_16x16x32_bf16 v[52:55], v[148:151], v[196:199], v[52:55]
  v_fmac_f32 v46, v32, v30
  v_fmac_f32 v47, v32, v31
  v_fma_f32 v40, v40, v34, v34
  ds_read_b128 v[220:223], v16 offset:23552
  v_mfma_f32_16x16x32_bf16 v[48:51], v[96:99], v[200:203], v[48:51]
  v_fma_f32 v41, v41, v34, v34
  v_fma_f32 v42, v42, v34, v34
  v_mfma_f32_16x16x32_bf16 v[52:55], v[152:155], v[200:203], v[52:55]
  v_fma_f32 v43, v43, v34, v34
  v_rcp_f32 v40, v40
  v_rcp_f32 v41, v41
  ds_read_b128 v[192:195], v16 offset:24576
  v_mfma_f32_16x16x32_bf16 v[48:51], v[100:103], v[204:207], v[48:51]
  v_rcp_f32 v42, v42
  v_rcp_f32 v43, v43
  v_mfma_f32_16x16x32_bf16 v[52:55], v[156:159], v[204:207], v[52:55]
  v_mul_f32 v40, v40, v44
  v_mul_f32 v41, v41, v45
  v_mul_f32 v42, v42, v46
  ds_read_b128 v[196:199], v16 offset:25600
  s_waitcnt lgkmcnt(5)
  v_mfma_f32_16x16x32_bf16 v[48:51], v[104:107], v[208:211], v[48:51]
  v_mul_f32 v43, v43, v47
  v_cvt_pk_bf16_f32 v56, v40, v41
  v_mfma_f32_16x16x32_bf16 v[52:55], v[160:163], v[208:211], v[52:55]
  v_cvt_pk_bf16_f32 v57, v42, v43
  ds_read_b128 v[200:203], v16 offset:26624
  s_waitcnt lgkmcnt(5)
  v_mfma_f32_16x16x32_bf16 v[48:51], v[108:111], v[212:215], v[48:51]
  v_mfma_f32_16x16x32_bf16 v[52:55], v[164:167], v[212:215], v[52:55]
  s_waitcnt vmcnt(4)
  s_barrier
  s_cmp_lg_u32 s44, 0
  s_cbranch_scc1 Lpub_19
  s_mov_b64 exec, 1
  v_mov_b32 v6, s47
  v_mov_b32 v7, 0
  buffer_store_dword v6, v7, s[36:39], s61 offen sc1
  s_mov_b64 exec, -1
Lpub_19:
  s_add_u32 s61, s61, 64
  s_setprio 3
  ds_read_b128 v[204:207], v16 offset:27648
  s_waitcnt lgkmcnt(5)
  v_mfma_f32_16x16x32_bf16 v[48:51], v[112:115], v[216:219], v[48:51]
  v_mfma_f32_16x16x32_bf16 v[52:55], v[168:171], v[216:219], v[52:55]
  ds_read_b128 v[208:211], v16 offset:28672
  s_waitcnt lgkmcnt(5)
  v_mfma_f32_16x16x32_bf16 v[48:51], v[116:119], v[220:223], v[48:51]
  v_mfma_f32_16x16x32_bf16 v[52:55], v[172:175], v[220:223], v[52:55]
  ds_read_b128 v[212:215], v16 offset:29696
  s_waitcnt lgkmcnt(5)
  v_mfma_f32_16x16x32_bf16 v[48:51], v[120:123], v[192:195], v[48:51]
  v_mfma_f32_16x16x32_bf16 v[52:55], v[176:179], v[192:195], v[52:55]
  s_add_u32 m0, s63, 32768
  s_mov_b32 s65, 143360
  buffer_load_dwordx4 v17, s[28:31], s65 offen lds
  ds_read_b128 v[216:219], v16 offset:30720
  s_waitcnt lgkmcnt(5)
  v_mfma_f32_16x16x32_bf16 v[48:51], v[124:127], v[196:199], v[48:51]
  v_mfma_f32_16x16x32_bf16 v[52:55], v[180:183], v[196:199], v[52:55]
  ds_read_b128 v[220:223], v16 offset:31744
  s_waitcnt lgkmcnt(5)
  v_mfma_f32_16x16x32_bf16 v[48:51], v[128:131], v[200:203], v[48:51]
  v_mfma_f32_16x16x32_bf16 v[52:55], v[184:187], v[200:203], v[52:55]
  s_add_u32 m0, s63, 33792
  s_mov_b32 s65, 146944
  buffer_load_dwordx4 v17, s[28:31], s65 offen lds
  ds_read_b128 v[192:195], v16 offset:32768
  s_waitcnt lgkmcnt(5)
  v_mfma_f32_16x16x32_bf16 v[48:51], v[132:135], v[204:207], v[48:51]
  v_mfma_f32_16x16x32_bf16 v[52:55], v[188:191], v[204:207], v[52:55]
  ds_read_b128 v[196:199], v16 offset:33792
  s_waitcnt lgkmcnt(5)
  v_mfma_f32_16x16x32_bf16 v[40:43], v[80:83], v[208:211], 0
  ds_read_b128 v[36:39], v19 offset:1280
  v_mfma_f32_16x16x32_bf16 v[44:47], v[136:139], v[208:211], 0
  s_waitcnt lgkmcnt(0)
  s_nop 0
  v_fmac_f32 v48, v36, v24
  v_fmac_f32 v49, v36, v25
  s_add_u32 m0, s63, 34816
  s_mov_b32 s65, 157696
  buffer_load_dwordx4 v17, s[28:31], s65 offen lds
  ds_read_b128 v[200:203], v16 offset:34816
  v_mfma_f32_16x16x32_bf16 v[40:43], v[84:87], v[212:215], v[40:43]
  v_fmac_f32 v50, v36, v26
  v_fmac_f32 v51, v36, v27
  v_mfma_f32_16x16x32_bf16 v[44:47], v[140:143], v[212:215], v[44:47]
  v_mul_f32 v48, v37, v48
  v_mul_f32 v49, v37, v49
  v_mul_f32 v50, v37, v50
  s_setprio 2
  ds_read_b128 v[204:207], v16 offset:35840
  v_mfma_f32_16x16x32_bf16 v[40:43], v[88:91], v[216:219], v[40:43]
  v_mul_f32 v51, v37, v51
  v_exp_f32 v48, v48
  v_mfma_f32_16x16x32_bf16 v[44:47], v[144:147], v[216:219], v[44:47]
  v_exp_f32 v49, v49
  v_exp_f32 v50, v50
  v_exp_f32 v51, v51
  s_add_u32 m0, s63, 35840
  s_mov_b32 s65, 161280
  buffer_load_dwordx4 v17, s[28:31], s65 offen lds
  ds_read_b128 v[208:211], v16 offset:36864
  v_mfma_f32_16x16x32_bf16 v[40:43], v[92:95], v[220:223], v[40:43]
  v_fmac_f32 v52, v36, v28
  v_fmac_f32 v53, v36, v29
  v_mfma_f32_16x16x32_bf16 v[44:47], v[148:151], v[220:223], v[44:47]
  v_fmac_f32 v54, v36, v30
  v_fmac_f32 v55, v36, v31
  v_fma_f32 v48, v48, v38, v38
  ds_read_b128 v[212:215], v16 offset:37888
  v_mfma_f32_16x16x32_bf16 v[40:43], v[96:99], v[192:195], v[40:43]
  v_fma_f32 v49, v49, v38, v38
  v_fma_f32 v50, v50, v38, v38
  v_mfma_f32_16x16x32_bf16 v[44:47], v[152:155], v[192:195], v[44:47]
  v_fma_f32 v51, v51, v38, v38
  v_rcp_f32 v48, v48
  v_rcp_f32 v49, v49
  s_waitcnt vmcnt(4)
  ds_read_b64_tr_b16 v[64:65], v8 offset:51200
  ds_read_b64_tr_b16 v[66:67], v8 offset:52224
  ds_read_b64_tr_b16 v[68:69], v9 offset:51200
  ds_read_b64_tr_b16 v[70:71], v9 offset:52224
  ds_read_b64_tr_b16 v[72:73], v10 offset:51200
  ds_read_b64_tr_b16 v[74:75], v10 offset:52224
  ds_read_b64_tr_b16 v[76:77], v11 offset:51200
  ds_read_b64_tr_b16 v[78:79], v11 offset:52224
  ds_read_b128 v[216:219], v16 offset:38912
  v_mfma_f32_16x16x32_bf16 v[40:43], v[100:103], v[196:199], v[40:43]
  v_rcp_f32 v50, v50
  v_rcp_f32 v51, v51
  v_mfma_f32_16x16x32_bf16 v[44:47], v[156:159], v[196:199], v[44:47]
  v_mul_f32 v48, v48, v52
  v_mul_f32 v49, v49, v53
  v_mul_f32 v50, v50, v54
  ds_read_b128 v[220:223], v16 offset:39936
  s_waitcnt lgkmcnt(13)
  v_mfma_f32_16x16x32_bf16 v[40:43], v[104:107], v[200:203], v[40:43]
  v_mul_f32 v51, v51, v55
  v_cvt_pk_bf16_f32 v58, v48, v49
  v_mfma_f32_16x16x32_bf16 v[44:47], v[160:163], v[200:203], v[44:47]
  v_cvt_pk_bf16_f32 v59, v50, v51
  v_permlane16_swap_b32 v56, v58
  s_nop 0
  v_permlane16_swap_b32 v57, v59
  ds_read_b128 v[192:195], v16 offset:40960
  s_waitcnt lgkmcnt(13)
  v_mfma_f32_16x16x32_bf16 v[40:43], v[108:111], v[204:207], v[40:43]
  buffer_store_dwordx4 v[56:59], v13, s[36:39], s58 offen sc1
  s_add_u32 s58, s58, 114688
  v_mfma_f32_16x16x32_bf16 v[44:47], v[164:167], v[204:207], v[44:47]
  ds_read_b128 v[196:199], v16 offset:41984
  s_waitcnt lgkmcnt(13)
  v_mfma_f32_16x16x32_bf16 v[40:43], v[112:115], v[208:211], v[40:43]
  v_mfma_f32_16x16x32_bf16 v[44:47], v[168:171], v[208:211], v[44:47]
  ds_read_b128 v[200:203], v16 offset:43008
  s_waitcnt lgkmcnt(13)
  v_mfma_f32_16x16x32_bf16 v[40:43], v[116:119], v[212:215], v[40:43]
  v_mfma_f32_16x16x32_bf16 v[44:47], v[172:175], v[212:215], v[44:47]
  ds_read_b128 v[204:207], v16 offset:44032
  s_waitcnt lgkmcnt(5)
  v_mfma_f32_16x16x32_bf16 v[40:43], v[120:123], v[216:219], v[40:43]
  v_mfma_f32_16x16x32_bf16 v[44:47], v[176:179], v[216:219], v[44:47]
  s_add_u32 m0, s63, 116736
  s_mov_b32 s65, 86016
  buffer_load_dwordx4 v17, s[28:31], s65 offen lds
  s_setprio 1
  ds_read_b128 v[208:211], v16 offset:45056
  s_waitcnt lgkmcnt(5)
  v_mfma_f32_16x16x32_bf16 v[40:43], v[124:127], v[220:223], v[40:43]
  v_mfma_f32_16x16x32_bf16 v[44:47], v[180:183], v[220:223], v[44:47]
  ds_read_b128 v[212:215], v16 offset:46080
  s_waitcnt lgkmcnt(5)
  v_mfma_f32_16x16x32_bf16 v[40:43], v[128:131], v[192:195], v[40:43]
  v_mfma_f32_16x16x32_bf16 v[44:47], v[184:187], v[192:195], v[44:47]
  s_add_u32 m0, s63, 117760
  s_mov_b32 s65, 89600
  buffer_load_dwordx4 v17, s[28:31], s65 offen lds
  ds_read_b128 v[216:219], v16 offset:47104
  s_waitcnt lgkmcnt(5)
  v_mfma_f32_16x16x32_bf16 v[40:43], v[132:135], v[196:199], v[40:43]
  v_mfma_f32_16x16x32_bf16 v[44:47], v[188:191], v[196:199], v[44:47]
  ds_read_b128 v[220:223], v16 offset:48128
  s_waitcnt lgkmcnt(5)
  v_mfma_f32_16x16x32_bf16 v[48:51], v[80:83], v[200:203], 0
  ds_read_b128 v[32:35], v19 offset:1536
  v_mfma_f32_16x16x32_bf16 v[52:55], v[136:139], v[200:203], 0
  s_waitcnt lgkmcnt(0)
  s_nop 0
  v_fmac_f32 v40, v32, v24
  v_fmac_f32 v41, v32, v25
  s_add_u32 m0, s63, 118784
  s_mov_b32 s65, 100352
  buffer_load_dwordx4 v17, s[28:31], s65 offen lds
  ds_read_b128 v[192:195], v16 offset:49152
  v_mfma_f32_16x16x32_bf16 v[48:51], v[84:87], v[204:207], v[48:51]
  v_fmac_f32 v42, v32, v26
  v_fmac_f32 v43, v32, v27
  v_mfma_f32_16x16x32_bf16 v[52:55], v[140:143], v[204:207], v[52:55]
  v_mul_f32 v40, v33, v40
  v_mul_f32 v41, v33, v41
  v_mul_f32 v42, v33, v42
  ds_read_b128 v[196:199], v16 offset:50176
  v_mfma_f32_16x16x32_bf16 v[48:51], v[88:91], v[208:211], v[48:51]
  v_mul_f32 v43, v33, v43
  v_exp_f32 v40, v40
  v_mfma_f32_16x16x32_bf16 v[52:55], v[144:147], v[208:211], v[52:55]
  v_exp_f32 v41, v41
  v_exp_f32 v42, v42
  v_exp_f32 v43, v43
  s_add_u32 m0, s63, 119808
  s_mov_b32 s65, 103936
  buffer_load_dwordx4 v17, s[28:31], s65 offen lds
  ds_read_b128 v[200:203], v16 offset:51200
  v_mfma_f32_16x16x32_bf16 v[48:51], v[92:95], v[212:215], v[48:51]
  v_fmac_f32 v44, v32, v28
  v_fmac_f32 v45, v32, v29
  v_mfma_f32_16x16x32_bf16 v[52:55], v[148:151], v[212:215], v[52:55]
  v_fmac_f32 v46, v32, v30
  v_fmac_f32 v47, v32, v31
  v_fma_f32 v40, v40, v34, v34
  ds_read_b128 v[204:207], v16 offset:52224
  v_mfma_f32_16x16x32_bf16 v[48:51], v[96:99], v[216:219], v[48:51]
  v_fma_f32 v41, v41, v34, v34
  v_fma_f32 v42, v42, v34, v34
  v_mfma_f32_16x16x32_bf16 v[52:55], v[152:155], v[216:219], v[52:55]
  v_fma_f32 v43, v43, v34, v34
  v_rcp_f32 v40, v40
  v_rcp_f32 v41, v41
  s_cmp_lg_u32 s44, 0
  s_cbranch_scc1 Lliss_20
  v_lshlrev_b32 v6, 2, v1
  buffer_load_dword v7, v6, s[36:39], s67 offen sc1
Lliss_20:
  s_setprio 0
  ds_read_b128 v[208:211], v16 offset:53248
  v_mfma_f32_16x16x32_bf16 v[48:51], v[100:103], v[220:223], v[48:51]
  v_rcp_f32 v42, v42
  v_rcp_f32 v43, v43
  v_mfma_f32_16x16x32_bf16 v[52:55], v[156:159], v[220:223], v[52:55]
  v_mul_f32 v40, v40, v44
  v_mul_f32 v41, v41, v45
  v_mul_f32 v42, v42, v46
  ds_read_b128 v[212:215], v16 offset:54272
  s_waitcnt lgkmcnt(5)
  v_mfma_f32_16x16x32_bf16 v[48:51], v[104:107], v[192:195], v[48:51]
  v_mul_f32 v43, v43, v47
  v_cvt_pk_bf16_f32 v60, v40, v41
  v_mfma_f32_16x16x32_bf16 v[52:55], v[160:163], v[192:195], v[52:55]
  v_cvt_pk_bf16_f32 v61, v42, v43
  ds_read_b128 v[216:219], v16 offset:55296
  s_waitcnt lgkmcnt(5)
  v_mfma_f32_16x16x32_bf16 v[48:51], v[108:111], v[196:199], v[48:51]
  v_mfma_f32_16x16x32_bf16 v[52:55], v[164:167], v[196:199], v[52:55]
  ds_read_b128 v[220:223], v16 offset:56320
  s_waitcnt lgkmcnt(5)
  v_mfma_f32_16x16x32_bf16 v[48:51], v[112:115], v[200:203], v[48:51]
  v_mfma_f32_16x16x32_bf16 v[52:55], v[168:171], v[200:203], v[52:55]
  s_waitcnt lgkmcnt(4)
  v_mfma_f32_16x16x32_bf16 v[48:51], v[116:119], v[204:207], v[48:51]
  v_mfma_f32_16x16x32_bf16 v[52:55], v[172:175], v[204:207], v[52:55]
  s_waitcnt lgkmcnt(3)
  v_mfma_f32_16x16x32_bf16 v[48:51], v[120:123], v[208:211], v[48:51]
  v_mfma_f32_16x16x32_bf16 v[52:55], v[176:179], v[208:211], v[52:55]
  s_waitcnt lgkmcnt(2)
  v_mfma_f32_16x16x32_bf16 v[48:51], v[124:127], v[212:215], v[48:51]
  v_mfma_f32_16x16x32_bf16 v[52:55], v[180:183], v[212:215], v[52:55]
  s_waitcnt lgkmcnt(1)
  v_mfma_f32_16x16x32_bf16 v[48:51], v[128:131], v[216:219], v[48:51]
  v_mfma_f32_16x16x32_bf16 v[52:55], v[184:187], v[216:219], v[52:55]
  s_waitcnt lgkmcnt(0)
  v_mfma_f32_16x16x32_bf16 v[48:51], v[132:135], v[220:223], v[48:51]
  v_mfma_f32_16x16x32_bf16 v[52:55], v[188:191], v[220:223], v[52:55]
  ds_read_b128 v[36:39], v19 offset:1792
  s_waitcnt vmcnt(4) lgkmcnt(0)
  s_cmp_lg_u32 s44, 0
  s_cbranch_scc1 Llskip_21
  s_mov_b32 s3, 400000
  s_waitcnt vmcnt(0)
  s_branch Llchk_23
Llpoll_22:
  buffer_load_dword v7, v6, s[36:39], s67 offen sc1
  s_waitcnt vmcnt(0)
Llchk_23:
  v_cmp_ne_u32 vcc, s47, v7
  s_sub_u32 s3, s3, 1
  s_cbranch_scc1 Lldone_24
  s_nop 0
  s_and_b32 vcc_lo, vcc_lo, 0x3fff3fff
  s_and_b32 vcc_hi, vcc_hi, 0x0
  s_cmp_lg_u64 vcc, 0
  s_cbranch_scc1 Llpoll_22
Lldone_24:
Llskip_21:
  s_barrier
  s_cmp_lg_u32 s44, 0
  s_cbranch_scc1 Lpub_25
  s_mov_b64 exec, 1
  v_mov_b32 v6, s47
  v_mov_b32 v7, 0
  buffer_store_dword v6, v7, s[36:39], s61 offen sc1
  s_mov_b64 exec, -1
Lpub_25:
  s_add_u32 s61, s61, 64
  v_fmac_f32 v48, v36, v24
  v_fmac_f32 v49, v36, v25
  v_fmac_f32 v50, v36, v26
  v_fmac_f32 v51, v36, v27
  v_mul_f32 v48, v37, v48
  v_mul_f32 v49, v37, v49
  v_mul_f32 v50, v37, v50
  v_mul_f32 v51, v37, v51
  v_exp_f32 v48, v48
  v_exp_f32 v49, v49
  v_exp_f32 v50, v50
  v_exp_f32 v51, v51
  v_fmac_f32 v52, v36, v28
  v_fmac_f32 v53, v36, v29
  v_fmac_f32 v54, v36, v30
  v_fmac_f32 v55, v36, v31
  v_fma_f32 v48, v48, v38, v38
  v_fma_f32 v49, v49, v38, v38
  v_fma_f32 v50, v50, v38, v38
  v_fma_f32 v51, v51, v38, v38
  v_rcp_f32 v48, v48
  v_rcp_f32 v49, v49
  v_rcp_f32 v50, v50
  v_rcp_f32 v51, v51
  v_mul_f32 v48, v48, v52
  v_mul_f32 v49, v49, v53
  v_mul_f32 v50, v50, v54
  v_mul_f32 v51, v51, v55
  v_cvt_pk_bf16_f32 v62, v48, v49
  v_cvt_pk_bf16_f32 v63, v50, v51
  s_nop 0
  v_permlane16_swap_b32 v60, v62
  v_permlane16_swap_b32 v61, v63
  buffer_store_dwordx4 v[60:63], v13, s[36:39], s58 offen sc1
  s_add_u32 s58, s58, 114688
  s_setprio 0
  v_add_u32 v16, 4096, v14
  buffer_load_dwordx4 v[176:179], v14, s[36:39], s68 offen offset:0 sc1
  buffer_load_dwordx4 v[180:183], v14, s[36:39], s68 offen offset:1024 sc1
  buffer_load_dwordx4 v[184:187], v14, s[36:39], s68 offen offset:2048 sc1
  buffer_load_dwordx4 v[188:191], v14, s[36:39], s68 offen offset:3072 sc1
  s_waitcnt vmcnt(5)
  ds_read_b64_tr_b16 v[80:81], v8 offset:51200
  ds_read_b64_tr_b16 v[82:83], v8 offset:52224
  ds_read_b64_tr_b16 v[84:85], v9 offset:51200
  ds_read_b64_tr_b16 v[86:87], v9 offset:52224
  ds_read_b64_tr_b16 v[88:89], v10 offset:51200
  ds_read_b64_tr_b16 v[90:91], v10 offset:52224
  ds_read_b64_tr_b16 v[92:93], v11 offset:51200
  ds_read_b64_tr_b16 v[94:95], v11 offset:52224
  v_subrev_u32 v8, 65536, v8
  v_subrev_u32 v9, 65536, v9
  v_subrev_u32 v10, 65536, v10
  v_subrev_u32 v11, 65536, v11
  ds_read_b64_tr_b16 v[96:97], v8 offset:0
  ds_read_b64_tr_b16 v[98:99], v8 offset:1024
  ds_read_b64_tr_b16 v[100:101], v9 offset:0
  ds_read_b64_tr_b16 v[102:103], v9 offset:1024
  ds_read_b64_tr_b16 v[104:105], v10 offset:0
  ds_read_b64_tr_b16 v[106:107], v10 offset:1024
  ds_read_b64_tr_b16 v[108:109], v11 offset:0
  ds_read_b64_tr_b16 v[110:111], v11 offset:1024
  ds_read_b64_tr_b16 v[112:113], v8 offset:32768
  ds_read_b64_tr_b16 v[114:115], v8 offset:33792
  ds_read_b64_tr_b16 v[116:117], v9 offset:32768
  ds_read_b64_tr_b16 v[118:119], v9 offset:33792
  ds_read_b64_tr_b16 v[120:121], v10 offset:32768
  ds_read_b64_tr_b16 v[122:123], v10 offset:33792
  ds_read_b64_tr_b16 v[124:125], v11 offset:32768
  ds_read_b64_tr_b16 v[126:127], v11 offset:33792
  v_add_u32 v8, 65536, v8
  v_add_u32 v9, 65536, v9
  v_add_u32 v10, 65536, v10
  v_add_u32 v11, 65536, v11
  v_lshrrev_b32 v18, 5, v1
  s_lshl_b32 s55, s44, 1
  v_add_u32 v18, s55, v18
  v_and_b32 v19, 31, v1
  v_lshrrev_b32 v20, 2, v19
  v_lshlrev_b32 v20, 8, v20
  v_lshl_add_u32 v20, v18, 4, v20
  v_lshl_add_u32 v20, v5, 2, v20
  v_add_u32 v20, 98304, v20
  v_mul_u32_u24 v21, 1792, v18
  v_lshl_add_u32 v21, v19, 2, v21
  v_lshrrev_b32 v22, 1, v19
  v_add_u32 v23, v22, v18
  v_and_b32 v23, 15, v23
  v_lshlrev_b32 v23, 4, v23
  v_lshl_add_u32 v22, v22, 8, v23
  v_and_b32 v23, 1, v19
  v_lshl_add_u32 v22, v23, 3, v22
  v_add_u32 v23, v2, v3
  v_lshl_add_u32 v28, v2, 8, s63
  v_add_u32 v29, 0, v23
  v_and_b32 v29, 15, v29
  v_lshl_add_u32 v24, v29, 4, v28
  v_add_u32 v29, 4, v23
  v_and_b32 v29, 15, v29
  v_lshl_add_u32 v25, v29, 4, v28
  v_add_u32 v29, 8, v23
  v_and_b32 v29, 15, v29
  v_lshl_add_u32 v26, v29, 4, v28
  v_add_u32 v29, 12, v23
  v_and_b32 v29, 15, v29
  v_lshl_add_u32 v27, v29, 4, v28
  s_waitcnt vmcnt(4) lgkmcnt(0)
  s_barrier
  s_cmp_lg_u32 s44, 0
  s_cbranch_scc1 Lpub_26
  s_mov_b64 exec, 1
  v_mov_b32 v6, s47
  v_mov_b32 v7, 0
  buffer_store_dword v6, v7, s[36:39], s61 offen sc1
  s_mov_b64 exec, -1
Lpub_26:
  s_add_u32 s61, s61, 64
  buffer_load_dwordx4 v[192:195], v16, s[36:39], s68 offen offset:0 sc1
  s_add_u32 m0, s53, 98304
  s_nop 0
  buffer_load_dwordx4 v14, s[36:39], s69 offen sc1 lds
  s_add_u32 m0, s63, 65536
  s_mov_b32 s65, 172032
  buffer_load_dwordx4 v17, s[28:31], s65 offen lds
  s_add_u32 m0, s63, 66560
  s_mov_b32 s65, 175616
  buffer_load_dwordx4 v17, s[28:31], s65 offen lds
  buffer_load_dwordx4 v[196:199], v16, s[36:39], s68 offen offset:1024 sc1
  s_waitcnt vmcnt(8)
  v_mfma_f32_16x16x32_bf16 v[144:147], v[224:227], v[176:179], 0
  v_mfma_f32_16x16x32_bf16 v[148:151], v[228:231], v[176:179], 0
  v_mfma_f32_16x16x32_bf16 v[152:155], v[232:235], v[176:179], 0
  v_mfma_f32_16x16x32_bf16 v[156:159], v[236:239], v[176:179], 0
  s_add_u32 m0, s63, 67584
  s_mov_b32 s65, 186368
  buffer_load_dwordx4 v17, s[28:31], s65 offen lds
  s_add_u32 m0, s63, 68608
  s_mov_b32 s65, 189952
  buffer_load_dwordx4 v17, s[28:31], s65 offen lds
  buffer_load_dwordx4 v[200:203], v16, s[36:39], s68 offen offset:2048 sc1
  s_add_u32 s68, s68, 114688
  s_waitcnt vmcnt(10)
  v_mfma_f32_16x16x32_bf16 v[144:147], v[240:243], v[180:183], v[144:147]
  v_mfma_f32_16x16x32_bf16 v[148:151], v[244:247], v[180:183], v[148:151]
  v_mfma_f32_16x16x32_bf16 v[152:155], v[248:251], v[180:183], v[152:155]
  v_mfma_f32_16x16x32_bf16 v[156:159], v[252:255], v[180:183], v[156:159]
  buffer_load_dwordx4 v[204:207], v14, s[36:39], s68 offen offset:0 sc1
  s_waitcnt vmcnt(10)
  v_mfma_f32_16x16x32_bf16 v[144:147], v[64:67], v[184:187], v[144:147]
  v_mfma_f32_16x16x32_bf16 v[148:151], v[68:71], v[184:187], v[148:151]
  v_mfma_f32_16x16x32_bf16 v[152:155], v[72:75], v[184:187], v[152:155]
  v_mfma_f32_16x16x32_bf16 v[156:159], v[76:79], v[184:187], v[156:159]
  buffer_load_dwordx4 v[208:211], v14, s[36:39], s68 offen offset:1024 sc1
  s_waitcnt vmcnt(10)
  v_mfma_f32_16x16x32_bf16 v[144:147], v[80:83], v[188:191], v[144:147]
  v_mfma_f32_16x16x32_bf16 v[148:151], v[84:87], v[188:191], v[148:151]
  v_mfma_f32_16x16x32_bf16 v[152:155], v[88:91], v[188:191], v[152:155]
  v_mfma_f32_16x16x32_bf16 v[156:159], v[92:95], v[188:191], v[156:159]
  buffer_load_dwordx4 v[212:215], v14, s[36:39], s68 offen offset:2048 sc1
  s_waitcnt vmcnt(10)
  v_mfma_f32_16x16x32_bf16 v[144:147], v[96:99], v[192:195], v[144:147]
  v_mfma_f32_16x16x32_bf16 v[148:151], v[100:103], v[192:195], v[148:151]
  v_mfma_f32_16x16x32_bf16 v[152:155], v[104:107], v[192:195], v[152:155]
  v_mfma_f32_16x16x32_bf16 v[156:159], v[108:111], v[192:195], v[156:159]
  s_waitcnt vmcnt(4)
  ds_read_b64_tr_b16 v[128:129], v8 offset:0
  ds_read_b64_tr_b16 v[130:131], v8 offset:1024
  ds_read_b64_tr_b16 v[132:133], v9 offset:0
  ds_read_b64_tr_b16 v[134:135], v9 offset:1024
  ds_read_b64_tr_b16 v[136:137], v10 offset:0
  ds_read_b64_tr_b16 v[138:139], v10 offset:1024
  ds_read_b64_tr_b16 v[140:141], v11 offset:0
  ds_read_b64_tr_b16 v[142:143], v11 offset:1024
  buffer_load_dwordx4 v[216:219], v14, s[36:39], s68 offen offset:3072 sc1
  v_mfma_f32_16x16x32_bf16 v[144:147], v[112:115], v[196:199], v[144:147]
  v_mfma_f32_16x16x32_bf16 v[148:151], v[116:119], v[196:199], v[148:151]
  v_mfma_f32_16x16x32_bf16 v[152:155], v[120:123], v[196:199], v[152:155]
  v_mfma_f32_16x16x32_bf16 v[156:159], v[124:127], v[196:199], v[156:159]
  s_cmp_lg_u32 s44, 0
  s_cbranch_scc1 Lliss_27
  v_lshlrev_b32 v6, 2, v1
  buffer_load_dword v7, v6, s[36:39], s67 offen sc1
Lliss_27:
  buffer_load_dwordx4 v[220:223], v16, s[36:39], s68 offen offset:0 sc1
  s_waitcnt vmcnt(5) lgkmcnt(6)
  v_mfma_f32_16x16x32_bf16 v[144:147], v[128:131], v[200:203], v[144:147]
  s_waitcnt lgkmcnt(4)
  v_mfma_f32_16x16x32_bf16 v[148:151], v[132:135], v[200:203], v[148:151]
  s_waitcnt lgkmcnt(2)
  v_mfma_f32_16x16x32_bf16 v[152:155], v[136:139], v[200:203], v[152:155]
  s_waitcnt lgkmcnt(0)
  v_mfma_f32_16x16x32_bf16 v[156:159], v[140:143], v[200:203], v[156:159]
  buffer_load_dwordx4 v[176:179], v16, s[36:39], s68 offen offset:1024 sc1
  s_waitcnt vmcnt(5)
  v_mfma_f32_16x16x32_bf16 v[160:163], v[224:227], v[204:207], 0
  v_mfma_f32_16x16x32_bf16 v[164:167], v[228:231], v[204:207], 0
  v_mfma_f32_16x16x32_bf16 v[168:171], v[232:235], v[204:207], 0
  v_mfma_f32_16x16x32_bf16 v[172:175], v[236:239], v[204:207], 0
  ds_write_b128 v24, v[144:147] offset:0
  buffer_load_dwordx4 v[180:183], v16, s[36:39], s68 offen offset:2048 sc1
  s_add_u32 s68, s68, 114688
  s_waitcnt vmcnt(5)
  v_mfma_f32_16x16x32_bf16 v[160:163], v[240:243], v[208:211], v[160:163]
  v_mfma_f32_16x16x32_bf16 v[164:167], v[244:247], v[208:211], v[164:167]
  ds_write_b128 v25, v[148:151] offset:1024
  v_mfma_f32_16x16x32_bf16 v[168:171], v[248:251], v[208:211], v[168:171]
  v_mfma_f32_16x16x32_bf16 v[172:175], v[252:255], v[208:211], v[172:175]
  ds_write_b128 v26, v[152:155] offset:2048
  s_waitcnt vmcnt(4)
  v_mfma_f32_16x16x32_bf16 v[160:163], v[64:67], v[212:215], v[160:163]
  v_mfma_f32_16x16x32_bf16 v[164:167], v[68:71], v[212:215], v[164:167]
  ds_write_b128 v27, v[156:159] offset:3072
  v_mfma_f32_16x16x32_bf16 v[168:171], v[72:75], v[212:215], v[168:171]
  v_mfma_f32_16x16x32_bf16 v[172:175], v[76:79], v[212:215], v[172:175]
  s_cmp_lg_u32 s44, 0
  s_cbranch_scc1 Llskip_28
  s_mov_b32 s3, 400000
  s_waitcnt vmcnt(3)
  s_branch Llchk_30
Llpoll_29:
  buffer_load_dword v7, v6, s[36:39], s67 offen sc1
  s_waitcnt vmcnt(0)
Llchk_30:
  v_cmp_ne_u32 vcc, s47, v7
  s_sub_u32 s3, s3, 1
  s_cbranch_scc1 Lldone_31
  s_nop 0
  s_and_b32 vcc_lo, vcc_lo, 0x0
  s_and_b32 vcc_hi, vcc_hi, 0x3fff
  s_cmp_lg_u64 vcc, 0
  s_cbranch_scc1 Llpoll_29
Lldone_31:
Llskip_28:
  s_waitcnt lgkmcnt(0)
  s_barrier
  buffer_load_dwordx4 v[184:187], v14, s[36:39], s68 offen offset:0 sc1
  buffer_load_dwordx4 v[188:191], v14, s[36:39], s68 offen offset:1024 sc1
  s_waitcnt vmcnt(5)
  v_mfma_f32_16x16x32_bf16 v[160:163], v[80:83], v[216:219], v[160:163]
  ds_read_b32 v49, v20 offset:0
  ds_read_b64 v[32:33], v22 offset:0
  v_mfma_f32_16x16x32_bf16 v[164:167], v[84:87], v[216:219], v[164:167]
  ds_read_b64 v[34:35], v22 offset:4096
  ds_read_b64 v[36:37], v22 offset:8192
  v_mfma_f32_16x16x32_bf16 v[168:171], v[88:91], v[216:219], v[168:171]
  ds_read_b64 v[38:39], v22 offset:12288
  ds_read_b64 v[40:41], v22 offset:16384
  v_mfma_f32_16x16x32_bf16 v[172:175], v[92:95], v[216:219], v[172:175]
  ds_read_b64 v[42:43], v22 offset:20480
  ds_read_b64 v[44:45], v22 offset:24576
  buffer_load_dwordx4 v[192:195], v14, s[36:39], s68 offen offset:2048 sc1
  s_waitcnt vmcnt(5)
  v_mfma_f32_16x16x32_bf16 v[160:163], v[96:99], v[220:223], v[160:163]
  ds_read_b64 v[46:47], v22 offset:28672
  s_waitcnt lgkmcnt(8)
  v_lshlrev_b32 v48, 16, v49
  v_mfma_f32_16x16x32_bf16 v[164:167], v[100:103], v[220:223], v[164:167]
  v_and_b32 v49, 0xffff0000, v49
  s_waitcnt lgkmcnt(6)
  v_add_f32 v32, v32, v34
  v_mfma_f32_16x16x32_bf16 v[168:171], v[104:107], v[220:223], v[168:171]
  v_add_f32 v33, v33, v35
  s_waitcnt lgkmcnt(4)
  v_add_f32 v36, v36, v38
  v_mfma_f32_16x16x32_bf16 v[172:175], v[108:111], v[220:223], v[172:175]
  v_add_f32 v37, v37, v39
  s_waitcnt lgkmcnt(2)
  v_add_f32 v40, v40, v42
  buffer_load_dwordx4 v[196:199], v14, s[36:39], s68 offen offset:3072 sc1
  s_waitcnt vmcnt(5)
  v_mfma_f32_16x16x32_bf16 v[160:163], v[112:115], v[176:179], v[160:163]
  v_add_f32 v41, v41, v43
  s_waitcnt lgkmcnt(0)
  v_add_f32 v44, v44, v46
  v_mfma_f32_16x16x32_bf16 v[164:167], v[116:119], v[176:179], v[164:167]
  v_add_f32 v45, v45, v47
  v_add_f32 v32, v32, v36
  v_mfma_f32_16x16x32_bf16 v[168:171], v[120:123], v[176:179], v[168:171]
  v_add_f32 v33, v33, v37
  v_add_f32 v40, v40, v44
  v_mfma_f32_16x16x32_bf16 v[172:175], v[124:127], v[176:179], v[172:175]
  v_add_f32 v41, v41, v45
  v_add_f32 v32, v32, v40
  s_cmp_lg_u32 s44, 0
  s_cbranch_scc1 Lliss_32
  v_lshlrev_b32 v6, 2, v1
  buffer_load_dword v7, v6, s[36:39], s67 offen sc1
Lliss_32:
  buffer_load_dwordx4 v[200:203], v16, s[36:39], s68 offen offset:0 sc1
  s_waitcnt vmcnt(5)
  v_mfma_f32_16x16x32_bf16 v[160:163], v[128:131], v[180:183], v[160:163]
  v_add_f32 v33, v33, v41
  v_add_f32 v48, v48, v32
  v_mfma_f32_16x16x32_bf16 v[164:167], v[132:135], v[180:183], v[164:167]
  v_add_f32 v49, v49, v33
  v_cvt_pk_bf16_f32 v50, v48, v49
  v_mfma_f32_16x16x32_bf16 v[168:171], v[136:139], v[180:183], v[168:171]
  buffer_store_dword v50, v21, s[32:35], s70 offen sc1
  s_add_u32 s70, s70, 28672
  v_mfma_f32_16x16x32_bf16 v[172:175], v[140:143], v[180:183], v[172:175]
  buffer_load_dwordx4 v[204:207], v16, s[36:39], s68 offen offset:1024 sc1
  s_waitcnt vmcnt(6)
  v_mfma_f32_16x16x32_bf16 v[144:147], v[224:227], v[184:187], 0
  v_mfma_f32_16x16x32_bf16 v[148:151], v[228:231], v[184:187], 0
  v_mfma_f32_16x16x32_bf16 v[152:155], v[232:235], v[184:187], 0
  v_mfma_f32_16x16x32_bf16 v[156:159], v[236:239], v[184:187], 0
  ds_write_b128 v24, v[160:163] offset:32768
  buffer_load_dwordx4 v[208:211], v16, s[36:39], s68 offen offset:2048 sc1
  s_add_u32 s68, s68, 114688
  s_waitcnt vmcnt(6)
  v_mfma_f32_16x16x32_bf16 v[144:147], v[240:243], v[188:191], v[144:147]
  v_mfma_f32_16x16x32_bf16 v[148:151], v[244:247], v[188:191], v[148:151]
  ds_write_b128 v25, v[164:167] offset:33792
  v_mfma_f32_16x16x32_bf16 v[152:155], v[248:251], v[188:191], v[152:155]
  v_mfma_f32_16x16x32_bf16 v[156:159], v[252:255], v[188:191], v[156:159]
  ds_write_b128 v26, v[168:171] offset:34816
  s_waitcnt vmcnt(5)
  v_mfma_f32_16x16x32_bf16 v[144:147], v[64:67], v[192:195], v[144:147]
  v_mfma_f32_16x16x32_bf16 v[148:151], v[68:71], v[192:195], v[148:151]
  ds_write_b128 v27, v[172:175] offset:35840
  v_mfma_f32_16x16x32_bf16 v[152:155], v[72:75], v[192:195], v[152:155]
  v_mfma_f32_16x16x32_bf16 v[156:159], v[76:79], v[192:195], v[156:159]
  s_cmp_lg_u32 s44, 0
  s_cbranch_scc1 Llskip_33
  s_mov_b32 s3, 400000
  s_waitcnt vmcnt(4)
  s_branch Llchk_35
Llpoll_34:
  buffer_load_dword v7, v6, s[36:39], s67 offen sc1
  s_waitcnt vmcnt(0)
Llchk_35:
  v_cmp_ne_u32 vcc, s47, v7
  s_sub_u32 s3, s3, 1
  s_cbranch_scc1 Lldone_36
  s_nop 0
  s_and_b32 vcc_lo, vcc_lo, 0x0
  s_and_b32 vcc_hi, vcc_hi, 0x3fff0000
  s_cmp_lg_u64 vcc, 0
  s_cbranch_scc1 Llpoll_34
Lldone_36:
Llskip_33:
  s_waitcnt lgkmcnt(0)
  s_barrier
  buffer_load_dwordx4 v[212:215], v14, s[36:39], s68 offen offset:0 sc1
  buffer_load_dwordx4 v[216:219], v14, s[36:39], s68 offen offset:1024 sc1
  s_waitcnt vmcnt(6)
  v_mfma_f32_16x16x32_bf16 v[144:147], v[80:83], v[196:199], v[144:147]
  ds_read_b32 v49, v20 offset:2048
  ds_read_b64 v[32:33], v22 offset:32768
  v_mfma_f32_16x16x32_bf16 v[148:151], v[84:87], v[196:199], v[148:151]
  ds_read_b64 v[34:35], v22 offset:36864
  ds_read_b64 v[36:37], v22 offset:40960
  v_mfma_f32_16x16x32_bf16 v[152:155], v[88:91], v[196:199], v[152:155]
  ds_read_b64 v[38:39], v22 offset:45056
  ds_read_b64 v[40:41], v22 offset:49152
  v_mfma_f32_16x16x32_bf16 v[156:159], v[92:95], v[196:199], v[156:159]
  ds_read_b64 v[42:43], v22 offset:53248
  ds_read_b64 v[44:45], v22 offset:57344
  buffer_load_dwordx4 v[220:223], v14, s[36:39], s68 offen offset:2048 sc1
  s_waitcnt vmcnt(6)
  v_mfma_f32_16x16x32_bf16 v[144:147], v[96:99], v[200:203], v[144:147]
  ds_read_b64 v[46:47], v22 offset:61440
  s_waitcnt lgkmcnt(8)
  v_lshlrev_b32 v48, 16, v49
  v_mfma_f32_16x16x32_bf16 v[148:151], v[100:103], v[200:203], v[148:151]
  v_and_b32 v49, 0xffff0000, v49
  s_waitcnt lgkmcnt(6)
  v_add_f32 v32, v32, v34
  v_mfma_f32_16x16x32_bf16 v[152:155], v[104:107], v[200:203], v[152:155]
  v_add_f32 v33, v33, v35
  s_waitcnt lgkmcnt(4)
  v_add_f32 v36, v36, v38
  v_mfma_f32_16x16x32_bf16 v[156:159], v[108:111], v[200:203], v[156:159]
  v_add_f32 v37, v37, v39
  s_waitcnt lgkmcnt(2)
  v_add_f32 v40, v40, v42
  buffer_load_dwordx4 v[176:179], v14, s[36:39], s68 offen offset:3072 sc1
  s_waitcnt vmcnt(5)
  v_mfma_f32_16x16x32_bf16 v[144:147], v[112:115], v[204:207], v[144:147]
  v_add_f32 v41, v41, v43
  s_waitcnt lgkmcnt(0)
  v_add_f32 v44, v44, v46
  v_mfma_f32_16x16x32_bf16 v[148:151], v[116:119], v[204:207], v[148:151]
  v_add_f32 v45, v45, v47
  v_add_f32 v32, v32, v36
  v_mfma_f32_16x16x32_bf16 v[152:155], v[120:123], v[204:207], v[152:155]
  v_add_f32 v33, v33, v37
  v_add_f32 v40, v40, v44
  v_mfma_f32_16x16x32_bf16 v[156:159], v[124:127], v[204:207], v[156:159]
  v_add_f32 v41, v41, v45
  v_add_f32 v32, v32, v40
  buffer_load_dwordx4 v[180:183], v16, s[36:39], s68 offen offset:0 sc1
  s_waitcnt vmcnt(5)
  v_mfma_f32_16x16x32_bf16 v[144:147], v[128:131], v[208:211], v[144:147]
  v_add_f32 v33, v33, v41
  v_add_f32 v48, v48, v32
  v_mfma_f32_16x16x32_bf16 v[148:151], v[132:135], v[208:211], v[148:151]
  v_add_f32 v49, v49, v33
  v_cvt_pk_bf16_f32 v51, v48, v49
  v_mfma_f32_16x16x32_bf16 v[152:155], v[136:139], v[208:211], v[152:155]
  buffer_store_dword v51, v21, s[32:35], s70 offen sc1
  s_add_u32 s70, s70, 28672
  v_mfma_f32_16x16x32_bf16 v[156:159], v[140:143], v[208:211], v[156:159]
  buffer_load_dwordx4 v[184:187], v16, s[36:39], s68 offen offset:1024 sc1
  s_waitcnt vmcnt(6)
  v_mfma_f32_16x16x32_bf16 v[160:163], v[224:227], v[212:215], 0
  v_mfma_f32_16x16x32_bf16 v[164:167], v[228:231], v[212:215], 0
  v_mfma_f32_16x16x32_bf16 v[168:171], v[232:235], v[212:215], 0
  v_mfma_f32_16x16x32_bf16 v[172:175], v[236:239], v[212:215], 0
  ds_write_b128 v24, v[144:147] offset:0
  buffer_load_dwordx4 v[188:191], v16, s[36:39], s68 offen offset:2048 sc1
  s_add_u32 s68, s68, 114688
  s_waitcnt vmcnt(6)
  v_mfma_f32_16x16x32_bf16 v[160:163], v[240:243], v[216:219], v[160:163]
  v_mfma_f32_16x16x32_bf16 v[164:167], v[244:247], v[216:219], v[164:167]
  ds_write_b128 v25, v[148:151] offset:1024
  v_mfma_f32_16x16x32_bf16 v[168:171], v[248:251], v[216:219], v[168:171]
  v_mfma_f32_16x16x32_bf16 v[172:175], v[252:255], v[216:219], v[172:175]
  ds_write_b128 v26, v[152:155] offset:2048
  s_waitcnt vmcnt(5)
  v_mfma_f32_16x16x32_bf16 v[160:163], v[64:67], v[220:223], v[160:163]
  v_mfma_f32_16x16x32_bf16 v[164:167], v[68:71], v[220:223], v[164:167]
  ds_write_b128 v27, v[156:159] offset:3072
  v_mfma_f32_16x16x32_bf16 v[168:171], v[72:75], v[220:223], v[168:171]
  v_mfma_f32_16x16x32_bf16 v[172:175], v[76:79], v[220:223], v[172:175]
  s_waitcnt lgkmcnt(0)
  s_barrier
  s_waitcnt vmcnt(4)
  v_mfma_f32_16x16x32_bf16 v[160:163], v[80:83], v[176:179], v[160:163]
  ds_read_b32 v49, v20 offset:4096
  ds_read_b64 v[32:33], v22 offset:0
  v_mfma_f32_16x16x32_bf16 v[164:167], v[84:87], v[176:179], v[164:167]
  ds_read_b64 v[34:35], v22 offset:4096
  ds_read_b64 v[36:37], v22 offset:8192
  v_mfma_f32_16x16x32_bf16 v[168:171], v[88:91], v[176:179], v[168:171]
  ds_read_b64 v[38:39], v22 offset:12288
  ds_read_b64 v[40:41], v22 offset:16384
  v_mfma_f32_16x16x32_bf16 v[172:175], v[92:95], v[176:179], v[172:175]
  ds_read_b64 v[42:43], v22 offset:20480
  ds_read_b64 v[44:45], v22 offset:24576
  s_waitcnt vmcnt(3)
  v_mfma_f32_16x16x32_bf16 v[160:163], v[96:99], v[180:183], v[160:163]
  ds_read_b64 v[46:47], v22 offset:28672
  s_waitcnt lgkmcnt(8)
  v_lshlrev_b32 v48, 16, v49
  v_mfma_f32_16x16x32_bf16 v[164:167], v[100:103], v[180:183], v[164:167]
  v_and_b32 v49, 0xffff0000, v49
  s_waitcnt lgkmcnt(6)
  v_add_f32 v32, v32, v34
  v_mfma_f32_16x16x32_bf16 v[168:171], v[104:107], v[180:183], v[168:171]
  v_add_f32 v33, v33, v35
  s_waitcnt lgkmcnt(4)
  v_add_f32 v36, v36, v38
  v_mfma_f32_16x16x32_bf16 v[172:175], v[108:111], v[180:183], v[172:175]
  v_add_f32 v37, v37, v39
  s_waitcnt lgkmcnt(2)
  v_add_f32 v40, v40, v42
  s_waitcnt vmcnt(1)
  v_mfma_f32_16x16x32_bf16 v[160:163], v[112:115], v[184:187], v[160:163]
  v_add_f32 v41, v41, v43
  s_waitcnt lgkmcnt(0)
  v_add_f32 v44, v44, v46
  v_mfma_f32_16x16x32_bf16 v[164:167], v[116:119], v[184:187], v[164:167]
  v_add_f32 v45, v45, v47
  v_add_f32 v32, v32, v36
  v_mfma_f32_16x16x32_bf16 v[168:171], v[120:123], v[184:187], v[168:171]
  v_add_f32 v33, v33, v37
  v_add_f32 v40, v40, v44
  v_mfma_f32_16x16x32_bf16 v[172:175], v[124:127], v[184:187], v[172:175]
  v_add_f32 v41, v41, v45
  v_add_f32 v32, v32, v40
  s_waitcnt vmcnt(0)
  v_mfma_f32_16x16x32_bf16 v[160:163], v[128:131], v[188:191], v[160:163]
  v_add_f32 v33, v33, v41
  v_add_f32 v48, v48, v32
  v_mfma_f32_16x16x32_bf16 v[164:167], v[132:135], v[188:191], v[164:167]
  v_add_f32 v49, v49, v33
  v_cvt_pk_bf16_f32 v52, v48, v49
  v_mfma_f32_16x16x32_bf16 v[168:171], v[136:139], v[188:191], v[168:171]
  buffer_store_dword v52, v21, s[32:35], s70 offen sc1
  s_add_u32 s70, s70, 28672
  v_mfma_f32_16x16x32_bf16 v[172:175], v[140:143], v[188:191], v[172:175]
  ds_write_b128 v24, v[160:163] offset:32768
  s_nop 0
  ds_write_b128 v25, v[164:167] offset:33792
  s_nop 1
  ds_write_b128 v26, v[168:171] offset:34816
  s_nop 1
  ds_write_b128 v27, v[172:175] offset:35840
  s_waitcnt lgkmcnt(0)
  s_barrier
  ds_read_b32 v49, v20 offset:6144
  ds_read_b64 v[32:33], v22 offset:32768
  ds_read_b64 v[34:35], v22 offset:36864
  ds_read_b64 v[36:37], v22 offset:40960
  ds_read_b64 v[38:39], v22 offset:45056
  ds_read_b64 v[40:41], v22 offset:49152
  ds_read_b64 v[42:43], v22 offset:53248
  ds_read_b64 v[44:45], v22 offset:57344
  ds_read_b64 v[46:47], v22 offset:61440
  s_waitcnt lgkmcnt(8)
  v_lshlrev_b32 v48, 16, v49
  v_and_b32 v49, 0xffff0000, v49
  s_waitcnt lgkmcnt(6)
  v_add_f32 v32, v32, v34
  v_add_f32 v33, v33, v35
  s_waitcnt lgkmcnt(4)
  v_add_f32 v36, v36, v38
  v_add_f32 v37, v37, v39
  s_waitcnt lgkmcnt(2)
  v_add_f32 v40, v40, v42
  v_add_f32 v41, v41, v43
  s_waitcnt lgkmcnt(0)
  v_add_f32 v44, v44, v46
  v_add_f32 v45, v45, v47
  v_add_f32 v32, v32, v36
  v_add_f32 v33, v33, v37
  v_add_f32 v40, v40, v44
  v_add_f32 v41, v41, v45
  v_add_f32 v32, v32, v40
  v_add_f32 v33, v33, v41
  v_add_f32 v48, v48, v32
  v_add_f32 v49, v49, v33
  v_cvt_pk_bf16_f32 v53, v48, v49
  buffer_store_dword v53, v21, s[32:35], s70 offen sc1
  s_add_u32 s70, s70, 28672
Lfin:
Lend:
  s_endpgm
Lcode_end:
.section .rodata,"a"
.p2align 6
.amdhsa_kernel sequential_preLN__sliding_local_dilated__glu_gated_glu__prompt_kernel
  .amdhsa_next_free_vgpr 256
  .amdhsa_next_free_sgpr 102
  .amdhsa_accum_offset 256
  .amdhsa_group_segment_fixed_size 0
  .amdhsa_kernarg_size 80
  .amdhsa_user_sgpr_count 2
  .amdhsa_user_sgpr_kernarg_segment_ptr 1
  .amdhsa_system_sgpr_workgroup_id_x 1
.end_amdhsa_kernel
```
